```python
import torch

def _softmax(x, axis=-1):
    return torch.softmax(x, dim=axis)
def _gelu(x):
    return torch.nn.functional.gelu(x, approximate="tanh")
def _silu(x):
    return torch.nn.functional.silu(x)
def _sigmoid(x):
    return torch.sigmoid(x)
def _layernorm(x, axis=-1, eps=1e-5):
    m = x.mean(dim=axis, keepdim=True)
    v = x.var(dim=axis, keepdim=True, unbiased=False)
    return (x - m) / torch.sqrt(v + eps)
def _scatter_add(tgt, idx, src, axis=0):
    return tgt.clone().index_add_(axis, idx, src)
def _segment_sum(src, seg, n):
    out = torch.zeros((n,) + src.shape[1:], dtype=src.dtype)
    return out.index_add_(0, seg, src)
def _pad(x, pw):
    flat = tuple(v for pair in reversed(pw) for v in pair)
    return torch.nn.functional.pad(x, flat)

kernel_name = 'concat_heads__sliding_block_cached__mha_block_cached__decode'

def setup_inputs():

    _w = (lambda a: (lambda t: t.to(torch.bfloat16) if t.is_floating_point() else t)(torch.as_tensor(a)))
    def _A_setup():
        B, Sq, D = 1, 1, 512
        Hq, Hkv, Sk, Dh = 32, 8, 16384, 128
        assert Hq % Hkv == 0, (Hq, Hkv)
        return {
            "x": _w((lambda *s: torch.randn(*s, dtype=torch.bfloat16) * 0.8)(B, Sq, D)),
            "k_cache": _w((lambda *s: torch.randn(*s, dtype=torch.bfloat16) * 1.6)(B, Hkv, Sk, Dh)),
            "v_cache": _w((lambda *s: torch.randn(*s, dtype=torch.bfloat16) * 0.2)(B, Hkv, Sk, Dh)),
            "wq": _w((lambda *s: torch.randn(*s, dtype=torch.bfloat16) * 1.6)(D, Hq * Dh) * (D ** -0.5)),
            "wo": _w((lambda *s: torch.randn(*s, dtype=torch.bfloat16) * 0.2)(Hq * Dh, D) * ((Hq * Dh) ** -0.5)),
        }
    _A_in = _A_setup()

    def _B_setup():
        B, Sq, D = 1, 1, 512
        H, Sk, Dh = 32, 16384, 128
        return {
            "x": _w((lambda *s: torch.randn(*s, dtype=torch.bfloat16) * 0.8)(B, Sq, D)),
            "k_cache": _w((lambda *s: torch.randn(*s, dtype=torch.bfloat16) * 1.6)(B, H, Sk, Dh)),
            "v_cache": _w((lambda *s: torch.randn(*s, dtype=torch.bfloat16) * 0.2)(B, H, Sk, Dh)),
            "wq": _w((lambda *s: torch.randn(*s, dtype=torch.bfloat16) * 1.6)(D, H * Dh) * (D ** -0.5)),
            "wo": _w((lambda *s: torch.randn(*s, dtype=torch.bfloat16) * 0.2)(H * Dh, D) * ((H * Dh) ** -0.5)),
        }
    _B_in = _B_setup()

    return {
        "A_x": _A_in["x"],
        "A_k_cache": _A_in["k_cache"],
        "A_v_cache": _A_in["v_cache"],
        "A_wq": _A_in["wq"],
        "A_wo": _A_in["wo"],
        "B_x": _B_in["x"],
        "B_k_cache": _B_in["k_cache"],
        "B_v_cache": _B_in["v_cache"],
        "B_wq": _B_in["wq"],
        "B_wo": _B_in["wo"],
    }

def reference(A_x, A_k_cache, A_v_cache, A_wq, A_wo, B_x, B_k_cache, B_v_cache, B_wq, B_wo):
    def _A_ref(x, k_cache, v_cache, wq, wo):
        B, Sq, D = x.shape
        Hq, Dh = 32, 128
        Hkv, Sk = k_cache.shape[1], k_cache.shape[2]
        W = min(4096, max(256, Sk // 4))
        rep = Hq // Hkv
        q = (lambda x, *d: x.permute(*d))((x @ wq).reshape(B, Sq, Hq, Dh), 0, 2, 1, 3)
        k = (lambda x, n, axis: torch.repeat_interleave(x, n, dim=axis))(k_cache[:, :, Sk - W:, :], rep, axis=1)
        v = (lambda x, n, axis: torch.repeat_interleave(x, n, dim=axis))(v_cache[:, :, Sk - W:, :], rep, axis=1)
        scores = torch.einsum("bhqd,bhkd->bhqk", q, k) * (Dh ** -0.5)
        p = _softmax(scores, axis=-1)
        o = torch.einsum("bhqk,bhkd->bhqd", p, v)
        return (lambda x, *d: x.permute(*d))(o, 0, 2, 1, 3).reshape(B, Sq, Hq * Dh) @ wo

    def _B_ref(x, k_cache, v_cache, wq, wo):
        B, Sq, D = x.shape
        H, Dh = 32, 128
        q = (lambda x, *d: x.permute(*d))((x @ wq).reshape(B, Sq, H, Dh), 0, 2, 1, 3)
        scores = torch.einsum("bhqd,bhkd->bhqk", q, k_cache) * (Dh ** -0.5)
        p = _softmax(scores, axis=-1)
        o = torch.einsum("bhqk,bhkd->bhqd", p, v_cache)
        return (lambda x, *d: x.permute(*d))(o, 0, 2, 1, 3).reshape(B, Sq, H * Dh) @ wo

    a = _A_ref(A_x, A_k_cache, A_v_cache, A_wq, A_wo)
    b = _B_ref(B_x, B_k_cache, B_v_cache, B_wq, B_wo)
    return torch.concatenate([a, b], axis=-1)
```

```asm
; @launch grid=(256,1,1) block=(512,1,1) lds=86016
.amdgcn_target "amdgcn-amd-amdhsa--gfx950"
.text
.globl concat_heads__sliding_block_cached__mha_block_cached__decode_kernel
.p2align 8
.type concat_heads__sliding_block_cached__mha_block_cached__decode_kernel,@function
concat_heads__sliding_block_cached__mha_block_cached__decode_kernel:
  s_load_dwordx16 s[16:31], s[0:1], 0
  s_load_dwordx8 s[32:39], s[0:1], 64
  s_load_dwordx2 s[40:41], s[0:1], 96
  s_cmp_ge_u32 s2, 256
  s_cbranch_scc1 L_end
  v_lshrrev_b32 v2, 6, v0
  v_and_b32 v1, 63, v0
  v_readfirstlane_b32 s3, v2
  v_and_b32 v2, 15, v1
  v_lshrrev_b32 v3, 4, v1
  v_lshlrev_b32 v5, 4, v1
  v_and_b32 v4, 3, v1
  v_lshlrev_b32 v4, 4, v4
  v_bfe_u32 v6, v1, 2, 2
  v_lshl_add_u32 v4, v6, 8, v4
  v_lshl_add_u32 v4, v3, 6, v4
  v_lshlrev_b32 v6, 4, v2
  v_lshl_add_u32 v6, v3, 13, v6
  s_and_b32 s4, s2, 7
  s_lshr_b32 s5, s2, 3
  s_lshl_b32 s6, s4, 2
  s_lshr_b32 s8, s5, 3
  s_add_u32 s6, s6, s8
  s_and_b32 s7, s5, 7
  s_mov_b32 s47, 0x20000
  s_mov_b32 s51, 0x20000
  s_mov_b32 s55, 0x20000
  s_mov_b32 s59, 0x20000
  s_mov_b32 s58, 1024
  s_cmp_eq_u32 s3, 7
  s_cbranch_scc1 L_ctrl
  s_lshl_b32 s8, s6, 22
  s_lshl_b32 s9, s7, 19
  s_add_u32 s8, s8, s9
  s_lshl_b32 s9, s6, 8
  s_lshl_b32 s76, s3, 12
  s_mov_b32 s46, 524288
  s_mov_b32 s50, 524288
  s_mov_b32 s54, 4186368
  v_mul_u32_u24 v7, 56, v2
  v_lshl_add_u32 v7, v3, 1, v7
  s_lshl_b32 s10, s3, 3
  s_lshl_b32 s11, s3, 15
  s_waitcnt lgkmcnt(0)
  s_add_u32 s44, s28, s8
  s_addc_u32 s45, s29, 0
  s_add_u32 s48, s30, s8
  s_addc_u32 s49, s31, 0
  s_mov_b32 s56, s26
  s_mov_b32 s57, s27
  s_add_u32 s52, s32, s9
  s_addc_u32 s53, s33, 0
  s_lshl_b32 s12, s7, 19
  s_add_u32 s13, s11, s12
  s_lshl_b32 s12, s7, 7
  s_add_u32 s12, s12, s10
  v_add_u32 v60, s12, v7
  v_and_b32 v60, 1023, v60
  v_add_u32 v61, 896, v7
  v_add_u32 v59, s10, v61
  v_add_u32 v61, s12, v61
  v_and_b32 v61, 1023, v61
  v_mov_b32 v58, 4096
  v_cmp_gt_u32 vcc, 1024, v59
  s_nop 1
  v_cndmask_b32 v61, v58, v61, vcc
  buffer_load_ushort v62, v60, s[56:59], 0 offen
  buffer_load_ushort v63, v61, s[56:59], 0 offen
  s_and_b32 s12, s13, 0x3fffff
  buffer_load_dwordx4 v[176:179], v6, s[52:55], s12 offen nt
  s_add_u32 s11, s11, 229376
  s_add_u32 s13, s13, 229376
  s_and_b32 s12, s13, 0x3fffff
  buffer_load_dwordx4 v[180:183], v6, s[52:55], s12 offen nt
  s_add_u32 s11, s11, 229376
  s_add_u32 s13, s13, 229376
  s_and_b32 s12, s13, 0x3fffff
  buffer_load_dwordx4 v[184:187], v6, s[52:55], s12 offen nt
  s_add_u32 s11, s11, 229376
  s_add_u32 s13, s13, 229376
  s_and_b32 s12, s13, 0x3fffff
  buffer_load_dwordx4 v[188:191], v6, s[52:55], s12 offen nt
  s_add_u32 s11, s11, 229376
  s_add_u32 s13, s13, 229376
  s_and_b32 s12, s13, 0x3fffff
  buffer_load_dwordx4 v[192:195], v6, s[52:55], s12 offen nt
  s_add_u32 s11, s11, 229376
  s_add_u32 s13, s13, 229376
  s_and_b32 s12, s13, 0x3fffff
  buffer_load_dwordx4 v[196:199], v6, s[52:55], s12 offen nt
  s_add_u32 s11, s11, 229376
  s_add_u32 s13, s13, 229376
  s_and_b32 s12, s13, 0x3fffff
  buffer_load_dwordx4 v[200:203], v6, s[52:55], s12 offen nt
  s_add_u32 s11, s11, 229376
  s_add_u32 s13, s13, 229376
  s_and_b32 s12, s13, 0x3fffff
  buffer_load_dwordx4 v[204:207], v6, s[52:55], s12 offen nt
  s_add_u32 s11, s11, 229376
  s_add_u32 s13, s13, 229376
  s_and_b32 s12, s13, 0x3fffff
  buffer_load_dwordx4 v[208:211], v6, s[52:55], s12 offen nt
  s_add_u32 s11, s11, 229376
  s_add_u32 s13, s13, 229376
  s_and_b32 s12, s13, 0x3fffff
  buffer_load_dwordx4 v[212:215], v6, s[52:55], s12 offen nt
  s_add_u32 s11, s11, 229376
  s_add_u32 s13, s13, 229376
  s_and_b32 s12, s13, 0x3fffff
  buffer_load_dwordx4 v[216:219], v6, s[52:55], s12 offen nt
  s_add_u32 s11, s11, 229376
  s_add_u32 s13, s13, 229376
  s_and_b32 s12, s13, 0x3fffff
  buffer_load_dwordx4 v[220:223], v6, s[52:55], s12 offen nt
  s_add_u32 s11, s11, 229376
  s_add_u32 s13, s13, 229376
  s_and_b32 s12, s13, 0x3fffff
  buffer_load_dwordx4 v[224:227], v6, s[52:55], s12 offen nt
  s_add_u32 s11, s11, 229376
  s_add_u32 s13, s13, 229376
  s_and_b32 s12, s13, 0x3fffff
  buffer_load_dwordx4 v[228:231], v6, s[52:55], s12 offen nt
  s_add_u32 s11, s11, 229376
  s_add_u32 s13, s13, 229376
  s_and_b32 s12, s13, 0x3fffff
  buffer_load_dwordx4 v[232:235], v6, s[52:55], s12 offen nt
  s_add_u32 s11, s11, 229376
  s_add_u32 s13, s13, 229376
  s_and_b32 s12, s13, 0x3fffff
  buffer_load_dwordx4 v[236:239], v6, s[52:55], s12 offen nt
  s_add_u32 s11, s11, 229376
  s_add_u32 s13, s13, 229376
  s_and_b32 s12, s13, 0x3fffff
  buffer_load_dwordx4 v[240:243], v6, s[52:55], s12 offen nt
  s_add_u32 s11, s11, 229376
  s_add_u32 s13, s13, 229376
  s_and_b32 s12, s13, 0x3fffff
  buffer_load_dwordx4 v[244:247], v6, s[52:55], s12 offen nt
  s_add_u32 s11, s11, 229376
  s_add_u32 s13, s13, 229376
  s_and_b32 s12, s13, 0x3fffff
  s_cmp_lt_u32 s11, 0x400000
  s_cselect_b32 s12, s12, 0x400000
  buffer_load_dwordx4 v[248:251], v6, s[52:55], s12 offen nt
  s_mov_b32 s77, s76
  v_and_b32 v48, 1, v2
  v_cmp_eq_u32 vcc, 1, v48
  v_mov_b32 v48, 0xffff
  v_mov_b32 v49, 0xffff0000
  v_cndmask_b32 v48, v48, v49, vcc
  v_lshrrev_b32 v49, 1, v2
  v_cmp_eq_u32 vcc, 0, v49
  s_nop 1
  v_cndmask_b32 v8, 0, v48, vcc
  v_cmp_eq_u32 vcc, 1, v49
  s_nop 1
  v_cndmask_b32 v9, 0, v48, vcc
  v_cmp_eq_u32 vcc, 2, v49
  s_nop 1
  v_cndmask_b32 v10, 0, v48, vcc
  v_cmp_eq_u32 vcc, 3, v49
  s_nop 1
  v_cndmask_b32 v11, 0, v48, vcc
  v_mov_b32 v45, 0x3fb8aa3b
  v_mov_b32 v46, 0xbfb8aa3b
  v_mov_b32 v43, 0
  v_mov_b32 v44, 0
  v_mov_b32 v28, 0
  v_mov_b32 v29, 0
  v_mov_b32 v30, 0
  v_mov_b32 v31, 0
  s_mov_b32 s80, 0xff800000
  v_lshlrev_b32 v48, 5, v2
  v_lshl_add_u32 v48, v3, 4, v48
  s_mul_i32 s8, s3, 512
  v_add_u32 v48, s8, v48
  v_and_b32 v49, 31, v1
  v_lshrrev_b32 v50, 5, v1
  v_lshlrev_b32 v51, 4, v49
  v_lshl_add_u32 v51, v50, 11, v51
  s_lshl_b32 s8, s3, 8
  s_add_u32 s8, s8, 4096
  v_lshlrev_b32 v52, 3, v49
  v_add_u32 v52, s8, v52
  v_and_b32 v53, 3, v1
  v_lshl_add_u32 v53, v3, 2, v53
  v_lshlrev_b32 v53, 4, v53
  v_add_u32 v53, s8, v53
  v_lshrrev_b32 v54, 2, v2
  s_waitcnt vmcnt(19)
  v_lshl_or_b32 v62, v62, 16, v62
  v_lshl_or_b32 v63, v63, 16, v63
  s_nop 0
  v_and_b32_dpp v36, v62, v8 row_newbcast:0 row_mask:0xf bank_mask:0xf
  v_and_b32_dpp v37, v62, v9 row_newbcast:0 row_mask:0xf bank_mask:0xf
  v_and_b32_dpp v38, v62, v10 row_newbcast:0 row_mask:0xf bank_mask:0xf
  v_and_b32_dpp v39, v62, v11 row_newbcast:0 row_mask:0xf bank_mask:0xf
  s_waitcnt vmcnt(18)
  s_nop 0
  v_mfma_f32_16x16x32_bf16 v[32:35], v[36:39], v[176:179], 0
  v_and_b32_dpp v36, v62, v8 row_newbcast:1 row_mask:0xf bank_mask:0xf
  v_and_b32_dpp v37, v62, v9 row_newbcast:1 row_mask:0xf bank_mask:0xf
  v_and_b32_dpp v38, v62, v10 row_newbcast:1 row_mask:0xf bank_mask:0xf
  v_and_b32_dpp v39, v62, v11 row_newbcast:1 row_mask:0xf bank_mask:0xf
  s_waitcnt vmcnt(17)
  s_nop 0
  v_mfma_f32_16x16x32_bf16 v[32:35], v[36:39], v[180:183], v[32:35]
  v_and_b32_dpp v36, v62, v8 row_newbcast:2 row_mask:0xf bank_mask:0xf
  v_and_b32_dpp v37, v62, v9 row_newbcast:2 row_mask:0xf bank_mask:0xf
  v_and_b32_dpp v38, v62, v10 row_newbcast:2 row_mask:0xf bank_mask:0xf
  v_and_b32_dpp v39, v62, v11 row_newbcast:2 row_mask:0xf bank_mask:0xf
  s_waitcnt vmcnt(16)
  s_nop 0
  v_mfma_f32_16x16x32_bf16 v[32:35], v[36:39], v[184:187], v[32:35]
  v_and_b32_dpp v36, v62, v8 row_newbcast:3 row_mask:0xf bank_mask:0xf
  v_and_b32_dpp v37, v62, v9 row_newbcast:3 row_mask:0xf bank_mask:0xf
  v_and_b32_dpp v38, v62, v10 row_newbcast:3 row_mask:0xf bank_mask:0xf
  v_and_b32_dpp v39, v62, v11 row_newbcast:3 row_mask:0xf bank_mask:0xf
  s_waitcnt vmcnt(15)
  s_nop 0
  v_mfma_f32_16x16x32_bf16 v[32:35], v[36:39], v[188:191], v[32:35]
  v_and_b32_dpp v36, v62, v8 row_newbcast:4 row_mask:0xf bank_mask:0xf
  v_and_b32_dpp v37, v62, v9 row_newbcast:4 row_mask:0xf bank_mask:0xf
  v_and_b32_dpp v38, v62, v10 row_newbcast:4 row_mask:0xf bank_mask:0xf
  v_and_b32_dpp v39, v62, v11 row_newbcast:4 row_mask:0xf bank_mask:0xf
  s_waitcnt vmcnt(14)
  s_nop 0
  v_mfma_f32_16x16x32_bf16 v[32:35], v[36:39], v[192:195], v[32:35]
  buffer_load_dwordx4 v[64:67], v4, s[44:47], s76 offen offset:0 nt
  v_and_b32_dpp v36, v62, v8 row_newbcast:5 row_mask:0xf bank_mask:0xf
  v_and_b32_dpp v37, v62, v9 row_newbcast:5 row_mask:0xf bank_mask:0xf
  v_and_b32_dpp v38, v62, v10 row_newbcast:5 row_mask:0xf bank_mask:0xf
  v_and_b32_dpp v39, v62, v11 row_newbcast:5 row_mask:0xf bank_mask:0xf
  s_waitcnt vmcnt(14)
  s_nop 0
  v_mfma_f32_16x16x32_bf16 v[32:35], v[36:39], v[196:199], v[32:35]
  buffer_load_dwordx4 v[68:71], v4, s[44:47], s76 offen offset:1024 nt
  v_and_b32_dpp v36, v62, v8 row_newbcast:6 row_mask:0xf bank_mask:0xf
  v_and_b32_dpp v37, v62, v9 row_newbcast:6 row_mask:0xf bank_mask:0xf
  v_and_b32_dpp v38, v62, v10 row_newbcast:6 row_mask:0xf bank_mask:0xf
  v_and_b32_dpp v39, v62, v11 row_newbcast:6 row_mask:0xf bank_mask:0xf
  s_waitcnt vmcnt(14)
  s_nop 0
  v_mfma_f32_16x16x32_bf16 v[32:35], v[36:39], v[200:203], v[32:35]
  buffer_load_dwordx4 v[72:75], v4, s[44:47], s76 offen offset:2048 nt
  v_and_b32_dpp v36, v62, v8 row_newbcast:7 row_mask:0xf bank_mask:0xf
  v_and_b32_dpp v37, v62, v9 row_newbcast:7 row_mask:0xf bank_mask:0xf
  v_and_b32_dpp v38, v62, v10 row_newbcast:7 row_mask:0xf bank_mask:0xf
  v_and_b32_dpp v39, v62, v11 row_newbcast:7 row_mask:0xf bank_mask:0xf
  s_waitcnt vmcnt(14)
  s_nop 0
  v_mfma_f32_16x16x32_bf16 v[32:35], v[36:39], v[204:207], v[32:35]
  buffer_load_dwordx4 v[76:79], v4, s[44:47], s76 offen offset:3072 nt
  v_and_b32_dpp v36, v62, v8 row_newbcast:8 row_mask:0xf bank_mask:0xf
  v_and_b32_dpp v37, v62, v9 row_newbcast:8 row_mask:0xf bank_mask:0xf
  v_and_b32_dpp v38, v62, v10 row_newbcast:8 row_mask:0xf bank_mask:0xf
  v_and_b32_dpp v39, v62, v11 row_newbcast:8 row_mask:0xf bank_mask:0xf
  s_waitcnt vmcnt(14)
  s_nop 0
  v_mfma_f32_16x16x32_bf16 v[32:35], v[36:39], v[208:211], v[32:35]
  buffer_load_dwordx4 v[80:83], v5, s[48:51], s76 offen offset:0 nt
  v_and_b32_dpp v36, v62, v8 row_newbcast:9 row_mask:0xf bank_mask:0xf
  v_and_b32_dpp v37, v62, v9 row_newbcast:9 row_mask:0xf bank_mask:0xf
  v_and_b32_dpp v38, v62, v10 row_newbcast:9 row_mask:0xf bank_mask:0xf
  v_and_b32_dpp v39, v62, v11 row_newbcast:9 row_mask:0xf bank_mask:0xf
  s_waitcnt vmcnt(14)
  s_nop 0
  v_mfma_f32_16x16x32_bf16 v[32:35], v[36:39], v[212:215], v[32:35]
  buffer_load_dwordx4 v[84:87], v5, s[48:51], s76 offen offset:1024 nt
  v_and_b32_dpp v36, v62, v8 row_newbcast:10 row_mask:0xf bank_mask:0xf
  v_and_b32_dpp v37, v62, v9 row_newbcast:10 row_mask:0xf bank_mask:0xf
  v_and_b32_dpp v38, v62, v10 row_newbcast:10 row_mask:0xf bank_mask:0xf
  v_and_b32_dpp v39, v62, v11 row_newbcast:10 row_mask:0xf bank_mask:0xf
  s_waitcnt vmcnt(14)
  s_nop 0
  v_mfma_f32_16x16x32_bf16 v[32:35], v[36:39], v[216:219], v[32:35]
  buffer_load_dwordx4 v[88:91], v5, s[48:51], s76 offen offset:2048 nt
  v_and_b32_dpp v36, v62, v8 row_newbcast:11 row_mask:0xf bank_mask:0xf
  v_and_b32_dpp v37, v62, v9 row_newbcast:11 row_mask:0xf bank_mask:0xf
  v_and_b32_dpp v38, v62, v10 row_newbcast:11 row_mask:0xf bank_mask:0xf
  v_and_b32_dpp v39, v62, v11 row_newbcast:11 row_mask:0xf bank_mask:0xf
  s_waitcnt vmcnt(14)
  s_nop 0
  v_mfma_f32_16x16x32_bf16 v[32:35], v[36:39], v[220:223], v[32:35]
  buffer_load_dwordx4 v[92:95], v5, s[48:51], s76 offen offset:3072 nt
  v_and_b32_dpp v36, v62, v8 row_newbcast:12 row_mask:0xf bank_mask:0xf
  v_and_b32_dpp v37, v62, v9 row_newbcast:12 row_mask:0xf bank_mask:0xf
  v_and_b32_dpp v38, v62, v10 row_newbcast:12 row_mask:0xf bank_mask:0xf
  v_and_b32_dpp v39, v62, v11 row_newbcast:12 row_mask:0xf bank_mask:0xf
  s_waitcnt vmcnt(14)
  s_nop 0
  v_mfma_f32_16x16x32_bf16 v[32:35], v[36:39], v[224:227], v[32:35]
  v_and_b32_dpp v36, v62, v8 row_newbcast:13 row_mask:0xf bank_mask:0xf
  v_and_b32_dpp v37, v62, v9 row_newbcast:13 row_mask:0xf bank_mask:0xf
  v_and_b32_dpp v38, v62, v10 row_newbcast:13 row_mask:0xf bank_mask:0xf
  v_and_b32_dpp v39, v62, v11 row_newbcast:13 row_mask:0xf bank_mask:0xf
  s_waitcnt vmcnt(13)
  s_nop 0
  v_mfma_f32_16x16x32_bf16 v[32:35], v[36:39], v[228:231], v[32:35]
  v_and_b32_dpp v36, v62, v8 row_newbcast:14 row_mask:0xf bank_mask:0xf
  v_and_b32_dpp v37, v62, v9 row_newbcast:14 row_mask:0xf bank_mask:0xf
  v_and_b32_dpp v38, v62, v10 row_newbcast:14 row_mask:0xf bank_mask:0xf
  v_and_b32_dpp v39, v62, v11 row_newbcast:14 row_mask:0xf bank_mask:0xf
  s_waitcnt vmcnt(12)
  s_nop 0
  v_mfma_f32_16x16x32_bf16 v[32:35], v[36:39], v[232:235], v[32:35]
  v_and_b32_dpp v36, v62, v8 row_newbcast:15 row_mask:0xf bank_mask:0xf
  v_and_b32_dpp v37, v62, v9 row_newbcast:15 row_mask:0xf bank_mask:0xf
  v_and_b32_dpp v38, v62, v10 row_newbcast:15 row_mask:0xf bank_mask:0xf
  v_and_b32_dpp v39, v62, v11 row_newbcast:15 row_mask:0xf bank_mask:0xf
  s_waitcnt vmcnt(11)
  s_nop 0
  v_mfma_f32_16x16x32_bf16 v[32:35], v[36:39], v[236:239], v[32:35]
  v_and_b32_dpp v36, v63, v8 row_newbcast:0 row_mask:0xf bank_mask:0xf
  v_and_b32_dpp v37, v63, v9 row_newbcast:0 row_mask:0xf bank_mask:0xf
  v_and_b32_dpp v38, v63, v10 row_newbcast:0 row_mask:0xf bank_mask:0xf
  v_and_b32_dpp v39, v63, v11 row_newbcast:0 row_mask:0xf bank_mask:0xf
  s_waitcnt vmcnt(10)
  s_nop 0
  v_mfma_f32_16x16x32_bf16 v[32:35], v[36:39], v[240:243], v[32:35]
  v_and_b32_dpp v36, v63, v8 row_newbcast:1 row_mask:0xf bank_mask:0xf
  v_and_b32_dpp v37, v63, v9 row_newbcast:1 row_mask:0xf bank_mask:0xf
  v_and_b32_dpp v38, v63, v10 row_newbcast:1 row_mask:0xf bank_mask:0xf
  v_and_b32_dpp v39, v63, v11 row_newbcast:1 row_mask:0xf bank_mask:0xf
  s_waitcnt vmcnt(9)
  s_nop 0
  v_mfma_f32_16x16x32_bf16 v[32:35], v[36:39], v[244:247], v[32:35]
  v_and_b32_dpp v36, v63, v8 row_newbcast:2 row_mask:0xf bank_mask:0xf
  v_and_b32_dpp v37, v63, v9 row_newbcast:2 row_mask:0xf bank_mask:0xf
  v_and_b32_dpp v38, v63, v10 row_newbcast:2 row_mask:0xf bank_mask:0xf
  v_and_b32_dpp v39, v63, v11 row_newbcast:2 row_mask:0xf bank_mask:0xf
  s_waitcnt vmcnt(8)
  s_nop 0
  v_mfma_f32_16x16x32_bf16 v[32:35], v[36:39], v[248:251], v[32:35]
  s_mov_b32 exec_hi, 0
  s_nop 6
  ds_write_b128 v48, v[32:35] offset:0
  s_mov_b64 exec, -1
  v_mov_b32 v188, 0
  v_mov_b32 v189, 0
  v_mov_b32 v190, 0
  v_mov_b32 v191, 0
  v_mov_b32 v55, 16000
  v_mov_b32 v56, 7
  v_mov_b32 v57, 1
  s_cmp_lg_u32 s3, 0
  s_cbranch_scc1 L_noinit
  ds_write_b32 v55, v56
L_noinit:
  s_waitcnt lgkmcnt(0)
  s_barrier
  ds_read_b128 v[176:179], v51 offset:0
  ds_read_b128 v[180:183], v51 offset:512
  ds_read_b128 v[184:187], v51 offset:1024
  s_mov_b32 exec_hi, 0
  ds_read_b128 v[188:191], v51 offset:1536
  s_mov_b32 exec_hi, -1
  s_waitcnt lgkmcnt(0)
  v_add_f32 v176, v176, v180
  v_add_f32 v184, v184, v188
  v_add_f32 v177, v177, v181
  v_add_f32 v185, v185, v189
  v_add_f32 v178, v178, v182
  v_add_f32 v186, v186, v190
  v_add_f32 v179, v179, v183
  v_add_f32 v187, v187, v191
  v_add_f32 v176, v176, v184
  v_add_f32 v177, v177, v185
  v_add_f32 v178, v178, v186
  v_add_f32 v179, v179, v187
  v_mov_b32 v180, v176
  v_mov_b32 v181, v177
  v_mov_b32 v182, v178
  v_mov_b32 v183, v179
  v_permlane32_swap_b32 v176, v180
  v_permlane32_swap_b32 v177, v181
  v_permlane32_swap_b32 v178, v182
  v_permlane32_swap_b32 v179, v183
  v_add_f32 v176, v176, v180
  v_add_f32 v177, v177, v181
  v_add_f32 v178, v178, v182
  v_add_f32 v179, v179, v183
  v_cvt_pk_bf16_f32 v184, v176, v177
  v_cvt_pk_bf16_f32 v185, v178, v179
  ds_write_b64 v52, v[184:185]
  ds_read_b128 v[188:191], v53
  s_waitcnt lgkmcnt(0)
  v_cmp_eq_u32 vcc, 0, v54
  s_nop 1
  v_cndmask_b32 v12, 0, v188, vcc
  v_cndmask_b32 v13, 0, v189, vcc
  v_cndmask_b32 v14, 0, v190, vcc
  v_cndmask_b32 v15, 0, v191, vcc
  v_cmp_eq_u32 vcc, 1, v54
  s_nop 1
  v_cndmask_b32 v16, 0, v188, vcc
  v_cndmask_b32 v17, 0, v189, vcc
  v_cndmask_b32 v18, 0, v190, vcc
  v_cndmask_b32 v19, 0, v191, vcc
  v_cmp_eq_u32 vcc, 2, v54
  s_nop 1
  v_cndmask_b32 v20, 0, v188, vcc
  v_cndmask_b32 v21, 0, v189, vcc
  v_cndmask_b32 v22, 0, v190, vcc
  v_cndmask_b32 v23, 0, v191, vcc
  v_cmp_eq_u32 vcc, 3, v54
  s_nop 1
  v_cndmask_b32 v24, 0, v188, vcc
  v_cndmask_b32 v25, 0, v189, vcc
  v_cndmask_b32 v26, 0, v190, vcc
  v_cndmask_b32 v27, 0, v191, vcc
  s_mov_b64 s[12:13], 0
  s_mov_b32 s14, s77
  s_mov_b64 exec, 1
  ds_add_rtn_u32 v56, v55, v57
  s_mov_b64 exec, -1
L_loop:
  s_cmp_ge_u32 s14, 524288
  s_cbranch_scc1 L_done
  s_mov_b32 s42, s14
  s_waitcnt lgkmcnt(0)
  v_readfirstlane_b32 s76, v56
  s_mov_b64 exec, 1
  ds_add_rtn_u32 v56, v55, v57
  s_mov_b64 exec, -1
  s_lshl_b32 s14, s76, 12
  s_waitcnt vmcnt(3)
  v_mfma_f32_16x16x32_bf16 v[32:35], v[64:67], v[12:15], 0
  s_mov_b64 exec, s[12:13]
  buffer_load_dwordx4 v[80:83], v5, s[48:51], s42 offen offset:0 nt
  s_mov_b64 exec, -1
  s_waitcnt vmcnt(3)
  v_mfma_f32_16x16x32_bf16 v[32:35], v[68:71], v[16:19], v[32:35]
  s_mov_b64 exec, s[12:13]
  buffer_load_dwordx4 v[84:87], v5, s[48:51], s42 offen offset:1024 nt
  s_mov_b64 exec, -1
  s_waitcnt vmcnt(3)
  v_mfma_f32_16x16x32_bf16 v[32:35], v[72:75], v[20:23], v[32:35]
  s_mov_b64 exec, s[12:13]
  buffer_load_dwordx4 v[88:91], v5, s[48:51], s42 offen offset:2048 nt
  s_mov_b64 exec, -1
  s_waitcnt vmcnt(3)
  v_mfma_f32_16x16x32_bf16 v[32:35], v[76:79], v[24:27], v[32:35]
  s_mov_b64 exec, s[12:13]
  buffer_load_dwordx4 v[92:95], v5, s[48:51], s42 offen offset:3072 nt
  s_mov_b64 exec, -1
  s_nop 4
  v_mov_b32_dpp v40, v32 quad_perm:[0,0,0,0] row_mask:0xf bank_mask:0xf
  v_add_f32_dpp v40, v33, v40 quad_perm:[1,1,1,1] row_mask:0xf bank_mask:0xf
  v_add_f32_dpp v40, v34, v40 quad_perm:[2,2,2,2] row_mask:0xf bank_mask:0xf
  v_add_f32_dpp v40, v35, v40 quad_perm:[3,3,3,3] row_mask:0xf bank_mask:0xf
  v_cvt_pk_bf16_f32 v41, v40, v40
  v_and_b32 v41, 0xffff0000, v41
  v_mul_f32 v41, 0x3db504f3, v41
  v_cvt_pk_bf16_f32 v41, v41, v41
  v_and_b32 v40, 0xffff0000, v41
  v_cmp_lt_f32 vcc, s80, v40
  s_cbranch_vccnz L_upd0
L_back0:
  v_fma_f32 v41, v40, v45, v44
  v_exp_f32 v41, v41
  s_nop 0
  v_cvt_pk_bf16_f32 v42, v41, v41
  v_add_f32 v43, v43, v41
  s_nop 0
  v_and_b32_dpp v36, v42, v8 row_newbcast:0 row_mask:0xf bank_mask:0xf
  v_and_b32_dpp v37, v42, v9 row_newbcast:0 row_mask:0xf bank_mask:0xf
  v_and_b32_dpp v38, v42, v10 row_newbcast:0 row_mask:0xf bank_mask:0xf
  v_and_b32_dpp v39, v42, v11 row_newbcast:0 row_mask:0xf bank_mask:0xf
  s_waitcnt vmcnt(3)
  s_nop 0
  v_mfma_f32_16x16x32_bf16 v[28:31], v[36:39], v[80:83], v[28:31]
  buffer_load_dwordx4 v[64:67], v4, s[44:47], s14 offen offset:0 nt
  v_and_b32_dpp v36, v42, v8 row_newbcast:4 row_mask:0xf bank_mask:0xf
  v_and_b32_dpp v37, v42, v9 row_newbcast:4 row_mask:0xf bank_mask:0xf
  v_and_b32_dpp v38, v42, v10 row_newbcast:4 row_mask:0xf bank_mask:0xf
  v_and_b32_dpp v39, v42, v11 row_newbcast:4 row_mask:0xf bank_mask:0xf
  s_waitcnt vmcnt(3)
  s_nop 0
  v_mfma_f32_16x16x32_bf16 v[28:31], v[36:39], v[84:87], v[28:31]
  buffer_load_dwordx4 v[68:71], v4, s[44:47], s14 offen offset:1024 nt
  v_and_b32_dpp v36, v42, v8 row_newbcast:8 row_mask:0xf bank_mask:0xf
  v_and_b32_dpp v37, v42, v9 row_newbcast:8 row_mask:0xf bank_mask:0xf
  v_and_b32_dpp v38, v42, v10 row_newbcast:8 row_mask:0xf bank_mask:0xf
  v_and_b32_dpp v39, v42, v11 row_newbcast:8 row_mask:0xf bank_mask:0xf
  s_waitcnt vmcnt(3)
  s_nop 0
  v_mfma_f32_16x16x32_bf16 v[28:31], v[36:39], v[88:91], v[28:31]
  buffer_load_dwordx4 v[72:75], v4, s[44:47], s14 offen offset:2048 nt
  v_and_b32_dpp v36, v42, v8 row_newbcast:12 row_mask:0xf bank_mask:0xf
  v_and_b32_dpp v37, v42, v9 row_newbcast:12 row_mask:0xf bank_mask:0xf
  v_and_b32_dpp v38, v42, v10 row_newbcast:12 row_mask:0xf bank_mask:0xf
  v_and_b32_dpp v39, v42, v11 row_newbcast:12 row_mask:0xf bank_mask:0xf
  s_waitcnt vmcnt(3)
  s_nop 0
  v_mfma_f32_16x16x32_bf16 v[28:31], v[36:39], v[92:95], v[28:31]
  buffer_load_dwordx4 v[76:79], v4, s[44:47], s14 offen offset:3072 nt
  s_mov_b64 s[12:13], -1
  s_branch L_loop
L_upd0:
  s_nop 1
  v_max_f32_dpp v41, v40, v40 row_ror:4 row_mask:0xf bank_mask:0xf
  s_nop 1
  v_max_f32_dpp v41, v41, v41 row_ror:8 row_mask:0xf bank_mask:0xf
  s_nop 1
  v_max_f32_dpp v41, v41, v41 row_bcast:15 row_mask:0xa bank_mask:0xf
  s_nop 1
  v_max_f32_dpp v41, v41, v41 row_bcast:31 row_mask:0xc bank_mask:0xf
  s_nop 0
  v_readlane_b32 s8, v41, 63
  v_mov_b32 v41, s80
  s_nop 0
  v_subrev_f32 v41, s8, v41
  v_mul_f32 v41, v45, v41
  v_exp_f32 v41, v41
  v_mul_f32 v44, s8, v46
  s_mov_b32 s80, s8
  v_mul_f32 v28, v41, v28
  v_mul_f32 v29, v41, v29
  v_mul_f32 v30, v41, v30
  v_mul_f32 v31, v41, v31
  v_mul_f32 v43, v41, v43
  s_branch L_back0
L_done:
  s_nop 1
  v_add_f32_dpp v43, v43, v43 row_ror:4 row_mask:0xf bank_mask:0xf
  s_nop 1
  v_add_f32_dpp v43, v43, v43 row_ror:8 row_mask:0xf bank_mask:0xf
  s_nop 1
  v_add_f32_dpp v43, v43, v43 row_bcast:15 row_mask:0xa bank_mask:0xf
  s_nop 1
  v_add_f32_dpp v43, v43, v43 row_bcast:31 row_mask:0xc bank_mask:0xf
  v_mov_b32 v42, s80
  s_mul_i32 s8, s3, 16
  v_add_u32 v48, s8, v48
  s_mul_i32 s8, s3, 528
  v_mov_b32 v49, s8
  s_mov_b32 exec_hi, 0
  ds_write_b128 v48, v[28:31] offset:8192
  s_mov_b32 s8, 0
  s_mov_b32 s9, 0x80000000
  s_mov_b64 exec, s[8:9]
  ds_write_b64 v49, v[42:43] offset:8704
  s_mov_b64 exec, -1
  s_waitcnt lgkmcnt(0)
  s_barrier
  s_endpgm
L_ctrl:
  s_mov_b32 s0, 300000
  s_setprio 3
  s_and_b32 s12, s5, 3
  s_lshl_b32 s13, s4, 2
  s_add_u32 s12, s12, s13
  s_lshr_b32 s13, s5, 2
  s_mov_b32 s63, 0x20000
  s_mov_b32 s67, 0x20000
  s_mov_b32 s71, 0x20000
  s_mov_b32 s75, 0x20000
  s_mov_b32 s62, 2097152
  s_mov_b32 s66, 256
  s_mov_b32 s70, 130176
  s_mov_b32 s74, 2048
  s_mov_b32 s46, 32768
  s_mov_b32 s50, 32768
  s_mov_b32 s54, 516352
  s_lshl_b32 s8, s4, 22
  s_lshl_b32 s9, s5, 15
  s_add_u32 s8, s8, s9
  s_add_u32 s8, s8, 3145728
  s_lshl_b32 s9, s12, 8
  s_lshl_b32 s10, s13, 19
  s_add_u32 s9, s9, s10
  s_lshl_b32 s10, s13, 7
  v_lshlrev_b32 v7, 3, v2
  v_lshl_add_u32 v7, v3, 1, v7
  s_waitcnt lgkmcnt(0)
  s_add_u32 s52, s22, s9
  s_addc_u32 s53, s23, 0
  s_mov_b32 s56, s16
  s_mov_b32 s57, s17
  s_add_u32 s44, s18, s8
  s_addc_u32 s45, s19, 0
  s_add_u32 s48, s20, s8
  s_addc_u32 s49, s21, 0
  s_mov_b32 s60, s40
  s_mov_b32 s61, s41
  s_mov_b32 s64, s38
  s_mov_b32 s65, s39
  s_mov_b32 s72, s36
  s_mov_b32 s73, s37
  buffer_load_ushort v57, v7, s[56:59], s10 offen
  s_mov_b32 s11, 0
  buffer_load_dwordx4 v[128:131], v6, s[52:55], s11 offen nt
  s_add_u32 s11, s11, 32768
  buffer_load_dwordx4 v[132:135], v6, s[52:55], s11 offen nt
  s_add_u32 s11, s11, 32768
  buffer_load_dwordx4 v[136:139], v6, s[52:55], s11 offen nt
  s_add_u32 s11, s11, 32768
  buffer_load_dwordx4 v[140:143], v6, s[52:55], s11 offen nt
  s_add_u32 s11, s11, 32768
  buffer_load_dwordx4 v[144:147], v6, s[52:55], s11 offen nt
  s_add_u32 s11, s11, 32768
  buffer_load_dwordx4 v[148:151], v6, s[52:55], s11 offen nt
  s_add_u32 s11, s11, 32768
  buffer_load_dwordx4 v[152:155], v6, s[52:55], s11 offen nt
  s_add_u32 s11, s11, 32768
  buffer_load_dwordx4 v[156:159], v6, s[52:55], s11 offen nt
  s_add_u32 s11, s11, 32768
  buffer_load_dwordx4 v[160:163], v6, s[52:55], s11 offen nt
  s_add_u32 s11, s11, 32768
  buffer_load_dwordx4 v[164:167], v6, s[52:55], s11 offen nt
  s_add_u32 s11, s11, 32768
  buffer_load_dwordx4 v[168:171], v6, s[52:55], s11 offen nt
  s_add_u32 s11, s11, 32768
  buffer_load_dwordx4 v[172:175], v6, s[52:55], s11 offen nt
  s_add_u32 s11, s11, 32768
  buffer_load_dwordx4 v[176:179], v6, s[52:55], s11 offen nt
  s_add_u32 s11, s11, 32768
  buffer_load_dwordx4 v[180:183], v6, s[52:55], s11 offen nt
  s_add_u32 s11, s11, 32768
  buffer_load_dwordx4 v[184:187], v6, s[52:55], s11 offen nt
  s_add_u32 s11, s11, 32768
  buffer_load_dwordx4 v[188:191], v6, s[52:55], s11 offen nt
  v_mov_b32 v104, -1
  v_mov_b32 v105, -1
  v_mov_b32 v106, -1
  v_mov_b32 v107, -1
  s_lshl_b32 s8, s4, 2
  s_lshl_b32 s8, s8, 5
  s_add_u32 s8, s8, s5
  s_mul_i32 s14, s8, 528
  s_add_u32 s14, s14, 131072
  s_lshl_b32 s8, s6, 3
  s_add_u32 s8, s8, s7
  s_mul_i32 s15, s8, 528
  s_add_u32 s15, s15, 671744
  s_mov_b32 s8, -1
  s_mov_b32 s9, 1
  s_mov_b64 exec, s[8:9]
  s_mov_b32 s10, s14
  buffer_store_dwordx4 v[104:107], v5, s[60:63], s10 offen sc1
  s_add_u32 s10, s10, 16896
  buffer_store_dwordx4 v[104:107], v5, s[60:63], s10 offen sc1
  s_add_u32 s10, s10, 16896
  buffer_store_dwordx4 v[104:107], v5, s[60:63], s10 offen sc1
  s_add_u32 s10, s10, 16896
  buffer_store_dwordx4 v[104:107], v5, s[60:63], s10 offen sc1
  buffer_store_dwordx4 v[104:107], v5, s[60:63], s15 offen sc1
  s_lshl_b32 s42, s13, 5
  s_add_u32 s42, s42, s12
  s_lshl_b32 s42, s42, 8
  s_add_u32 s42, s42, 806912
  s_lshl_b32 s43, s7, 5
  s_add_u32 s43, s43, s6
  s_lshl_b32 s43, s43, 8
  s_add_u32 s43, s43, 872448
  s_mov_b64 exec, 0xffff
  buffer_store_dwordx4 v[104:107], v5, s[60:63], s42 offen sc1
  buffer_store_dwordx4 v[104:107], v5, s[60:63], s43 offen sc1
  s_mov_b64 exec, -1
  v_and_b32 v58, 1, v2
  v_cmp_eq_u32 vcc, 1, v58
  v_mov_b32 v58, 0xffff
  v_mov_b32 v59, 0xffff0000
  v_cndmask_b32 v58, v58, v59, vcc
  v_lshrrev_b32 v59, 1, v2
  v_cmp_eq_u32 vcc, 0, v59
  s_nop 1
  v_cndmask_b32 v8, 0, v58, vcc
  v_cmp_eq_u32 vcc, 1, v59
  s_nop 1
  v_cndmask_b32 v9, 0, v58, vcc
  v_cmp_eq_u32 vcc, 2, v59
  s_nop 1
  v_cndmask_b32 v10, 0, v58, vcc
  v_cmp_eq_u32 vcc, 3, v59
  s_nop 1
  v_cndmask_b32 v11, 0, v58, vcc
  v_and_b32 v60, 7, v2
  v_and_b32 v58, 1, v60
  v_cmp_eq_u32 vcc, 1, v58
  v_mov_b32 v58, 0xffff
  v_mov_b32 v59, 0xffff0000
  v_cndmask_b32 v58, v58, v59, vcc
  v_lshrrev_b32 v59, 1, v60
  v_cmp_eq_u32 vcc, 0, v59
  s_nop 1
  v_cndmask_b32 v12, 0, v58, vcc
  v_cmp_eq_u32 vcc, 1, v59
  s_nop 1
  v_cndmask_b32 v13, 0, v58, vcc
  v_cmp_eq_u32 vcc, 2, v59
  s_nop 1
  v_cndmask_b32 v14, 0, v58, vcc
  v_cmp_eq_u32 vcc, 3, v59
  s_nop 1
  v_cndmask_b32 v15, 0, v58, vcc
  v_mov_b32 v55, 0x3fb8aa3b
  v_mov_b32 v56, 0xbfb8aa3b
  v_mov_b32 v112, 0
  v_mov_b32 v113, 0
  v_mov_b32 v114, 0
  v_mov_b32 v115, 0
  v_mov_b32 v116, 0xff800000
  v_mov_b32 v117, 0
  v_mov_b32 v118, 0
  s_mov_b32 exec_hi, 0
  ds_write_b128 v5, v[112:115] offset:11888
  ds_write_b64 v118, v[116:117] offset:12400
  s_mov_b64 exec, -1
  v_and_b32 v58, 31, v1
  v_lshrrev_b32 v59, 5, v1
  v_lshlrev_b32 v96, 4, v58
  v_lshl_add_u32 v98, v59, 9, v96
  v_mul_u32_u24 v97, 528, v59
  v_add_u32 v96, v97, v96
  v_lshlrev_b32 v99, 5, v2
  v_and_b32 v60, 1, v3
  v_lshl_add_u32 v99, v60, 4, v99
  v_lshrrev_b32 v60, 3, v2
  v_lshl_add_u32 v60, v3, 1, v60
  v_and_b32 v61, 7, v2
  v_lshlrev_b32 v7, 4, v61
  v_lshl_add_u32 v7, v60, 10, v7
  v_lshlrev_b32 v100, 6, v60
  v_and_b32 v101, 1, v58
  v_lshlrev_b32 v101, 8, v101
  v_lshrrev_b32 v61, 1, v58
  v_lshl_add_u32 v101, v61, 2, v101
  v_lshlrev_b32 v102, 3, v58
  s_barrier
  s_waitcnt vmcnt(23)
  v_lshl_or_b32 v57, v57, 16, v57
  s_nop 1
  v_and_b32_dpp v44, v57, v8 row_newbcast:0 row_mask:0xf bank_mask:0xf
  v_and_b32_dpp v45, v57, v9 row_newbcast:0 row_mask:0xf bank_mask:0xf
  v_and_b32_dpp v46, v57, v10 row_newbcast:0 row_mask:0xf bank_mask:0xf
  v_and_b32_dpp v47, v57, v11 row_newbcast:0 row_mask:0xf bank_mask:0xf
  s_waitcnt vmcnt(22)
  s_nop 0
  v_mfma_f32_16x16x32_bf16 v[28:31], v[44:47], v[128:131], 0
  v_and_b32_dpp v44, v57, v8 row_newbcast:1 row_mask:0xf bank_mask:0xf
  v_and_b32_dpp v45, v57, v9 row_newbcast:1 row_mask:0xf bank_mask:0xf
  v_and_b32_dpp v46, v57, v10 row_newbcast:1 row_mask:0xf bank_mask:0xf
  v_and_b32_dpp v47, v57, v11 row_newbcast:1 row_mask:0xf bank_mask:0xf
  s_waitcnt vmcnt(21)
  s_nop 0
  v_mfma_f32_16x16x32_bf16 v[28:31], v[44:47], v[132:135], v[28:31]
  v_and_b32_dpp v44, v57, v8 row_newbcast:2 row_mask:0xf bank_mask:0xf
  v_and_b32_dpp v45, v57, v9 row_newbcast:2 row_mask:0xf bank_mask:0xf
  v_and_b32_dpp v46, v57, v10 row_newbcast:2 row_mask:0xf bank_mask:0xf
  v_and_b32_dpp v47, v57, v11 row_newbcast:2 row_mask:0xf bank_mask:0xf
  s_waitcnt vmcnt(20)
  s_nop 0
  v_mfma_f32_16x16x32_bf16 v[28:31], v[44:47], v[136:139], v[28:31]
  v_and_b32_dpp v44, v57, v8 row_newbcast:3 row_mask:0xf bank_mask:0xf
  v_and_b32_dpp v45, v57, v9 row_newbcast:3 row_mask:0xf bank_mask:0xf
  v_and_b32_dpp v46, v57, v10 row_newbcast:3 row_mask:0xf bank_mask:0xf
  v_and_b32_dpp v47, v57, v11 row_newbcast:3 row_mask:0xf bank_mask:0xf
  s_waitcnt vmcnt(19)
  s_nop 0
  v_mfma_f32_16x16x32_bf16 v[28:31], v[44:47], v[140:143], v[28:31]
  v_and_b32_dpp v44, v57, v8 row_newbcast:4 row_mask:0xf bank_mask:0xf
  v_and_b32_dpp v45, v57, v9 row_newbcast:4 row_mask:0xf bank_mask:0xf
  v_and_b32_dpp v46, v57, v10 row_newbcast:4 row_mask:0xf bank_mask:0xf
  v_and_b32_dpp v47, v57, v11 row_newbcast:4 row_mask:0xf bank_mask:0xf
  s_waitcnt vmcnt(18)
  s_nop 0
  v_mfma_f32_16x16x32_bf16 v[28:31], v[44:47], v[144:147], v[28:31]
  v_and_b32_dpp v44, v57, v8 row_newbcast:5 row_mask:0xf bank_mask:0xf
  v_and_b32_dpp v45, v57, v9 row_newbcast:5 row_mask:0xf bank_mask:0xf
  v_and_b32_dpp v46, v57, v10 row_newbcast:5 row_mask:0xf bank_mask:0xf
  v_and_b32_dpp v47, v57, v11 row_newbcast:5 row_mask:0xf bank_mask:0xf
  s_waitcnt vmcnt(17)
  s_nop 0
  v_mfma_f32_16x16x32_bf16 v[28:31], v[44:47], v[148:151], v[28:31]
  v_and_b32_dpp v44, v57, v8 row_newbcast:6 row_mask:0xf bank_mask:0xf
  v_and_b32_dpp v45, v57, v9 row_newbcast:6 row_mask:0xf bank_mask:0xf
  v_and_b32_dpp v46, v57, v10 row_newbcast:6 row_mask:0xf bank_mask:0xf
  v_and_b32_dpp v47, v57, v11 row_newbcast:6 row_mask:0xf bank_mask:0xf
  s_waitcnt vmcnt(16)
  s_nop 0
  v_mfma_f32_16x16x32_bf16 v[28:31], v[44:47], v[152:155], v[28:31]
  v_and_b32_dpp v44, v57, v8 row_newbcast:7 row_mask:0xf bank_mask:0xf
  v_and_b32_dpp v45, v57, v9 row_newbcast:7 row_mask:0xf bank_mask:0xf
  v_and_b32_dpp v46, v57, v10 row_newbcast:7 row_mask:0xf bank_mask:0xf
  v_and_b32_dpp v47, v57, v11 row_newbcast:7 row_mask:0xf bank_mask:0xf
  s_waitcnt vmcnt(15)
  s_nop 0
  v_mfma_f32_16x16x32_bf16 v[28:31], v[44:47], v[156:159], v[28:31]
  v_and_b32_dpp v44, v57, v8 row_newbcast:8 row_mask:0xf bank_mask:0xf
  v_and_b32_dpp v45, v57, v9 row_newbcast:8 row_mask:0xf bank_mask:0xf
  v_and_b32_dpp v46, v57, v10 row_newbcast:8 row_mask:0xf bank_mask:0xf
  v_and_b32_dpp v47, v57, v11 row_newbcast:8 row_mask:0xf bank_mask:0xf
  s_waitcnt vmcnt(14)
  s_nop 0
  v_mfma_f32_16x16x32_bf16 v[28:31], v[44:47], v[160:163], v[28:31]
  v_and_b32_dpp v44, v57, v8 row_newbcast:9 row_mask:0xf bank_mask:0xf
  v_and_b32_dpp v45, v57, v9 row_newbcast:9 row_mask:0xf bank_mask:0xf
  v_and_b32_dpp v46, v57, v10 row_newbcast:9 row_mask:0xf bank_mask:0xf
  v_and_b32_dpp v47, v57, v11 row_newbcast:9 row_mask:0xf bank_mask:0xf
  s_waitcnt vmcnt(13)
  s_nop 0
  v_mfma_f32_16x16x32_bf16 v[28:31], v[44:47], v[164:167], v[28:31]
  v_and_b32_dpp v44, v57, v8 row_newbcast:10 row_mask:0xf bank_mask:0xf
  v_and_b32_dpp v45, v57, v9 row_newbcast:10 row_mask:0xf bank_mask:0xf
  v_and_b32_dpp v46, v57, v10 row_newbcast:10 row_mask:0xf bank_mask:0xf
  v_and_b32_dpp v47, v57, v11 row_newbcast:10 row_mask:0xf bank_mask:0xf
  s_waitcnt vmcnt(12)
  s_nop 0
  v_mfma_f32_16x16x32_bf16 v[28:31], v[44:47], v[168:171], v[28:31]
  v_and_b32_dpp v44, v57, v8 row_newbcast:11 row_mask:0xf bank_mask:0xf
  v_and_b32_dpp v45, v57, v9 row_newbcast:11 row_mask:0xf bank_mask:0xf
  v_and_b32_dpp v46, v57, v10 row_newbcast:11 row_mask:0xf bank_mask:0xf
  v_and_b32_dpp v47, v57, v11 row_newbcast:11 row_mask:0xf bank_mask:0xf
  s_waitcnt vmcnt(11)
  s_nop 0
  v_mfma_f32_16x16x32_bf16 v[28:31], v[44:47], v[172:175], v[28:31]
  v_and_b32_dpp v44, v57, v8 row_newbcast:12 row_mask:0xf bank_mask:0xf
  v_and_b32_dpp v45, v57, v9 row_newbcast:12 row_mask:0xf bank_mask:0xf
  v_and_b32_dpp v46, v57, v10 row_newbcast:12 row_mask:0xf bank_mask:0xf
  v_and_b32_dpp v47, v57, v11 row_newbcast:12 row_mask:0xf bank_mask:0xf
  s_waitcnt vmcnt(10)
  s_nop 0
  v_mfma_f32_16x16x32_bf16 v[28:31], v[44:47], v[176:179], v[28:31]
  v_and_b32_dpp v44, v57, v8 row_newbcast:13 row_mask:0xf bank_mask:0xf
  v_and_b32_dpp v45, v57, v9 row_newbcast:13 row_mask:0xf bank_mask:0xf
  v_and_b32_dpp v46, v57, v10 row_newbcast:13 row_mask:0xf bank_mask:0xf
  v_and_b32_dpp v47, v57, v11 row_newbcast:13 row_mask:0xf bank_mask:0xf
  s_waitcnt vmcnt(9)
  s_nop 0
  v_mfma_f32_16x16x32_bf16 v[28:31], v[44:47], v[180:183], v[28:31]
  v_and_b32_dpp v44, v57, v8 row_newbcast:14 row_mask:0xf bank_mask:0xf
  v_and_b32_dpp v45, v57, v9 row_newbcast:14 row_mask:0xf bank_mask:0xf
  v_and_b32_dpp v46, v57, v10 row_newbcast:14 row_mask:0xf bank_mask:0xf
  v_and_b32_dpp v47, v57, v11 row_newbcast:14 row_mask:0xf bank_mask:0xf
  s_waitcnt vmcnt(8)
  s_nop 0
  v_mfma_f32_16x16x32_bf16 v[28:31], v[44:47], v[184:187], v[28:31]
  v_and_b32_dpp v44, v57, v8 row_newbcast:15 row_mask:0xf bank_mask:0xf
  v_and_b32_dpp v45, v57, v9 row_newbcast:15 row_mask:0xf bank_mask:0xf
  v_and_b32_dpp v46, v57, v10 row_newbcast:15 row_mask:0xf bank_mask:0xf
  v_and_b32_dpp v47, v57, v11 row_newbcast:15 row_mask:0xf bank_mask:0xf
  s_waitcnt vmcnt(7)
  s_nop 0
  v_mfma_f32_16x16x32_bf16 v[28:31], v[44:47], v[188:191], v[28:31]
  s_lshl_b32 s8, s12, 3
  s_add_u32 s8, s8, s13
  s_lshl_b32 s8, s8, 9
  s_add_u32 s8, s8, 0
  s_mov_b32 exec_hi, 0
  s_nop 2
  buffer_store_dwordx4 v[28:31], v99, s[60:63], s8 offen sc1
  s_mov_b64 exec, -1
  s_waitcnt vmcnt(0)
  s_and_b32 s8, s2, 63
  s_lshl_b32 s8, s8, 2
  s_add_u32 s8, s8, 0
  v_mov_b32 v57, 1
  v_mov_b32 v58, 0
  s_mov_b64 exec, 1
  buffer_atomic_add v57, v58, s[64:67], s8 offen sc1
  s_mov_b64 exec, -1
  v_and_b32 v58, 63, v1
  v_lshlrev_b32 v58, 2, v58
  s_mov_b32 s76, 0
L_dma:
  s_add_u32 m0, s76, 20480
  s_nop 0
  buffer_load_dwordx4 v4, s[44:47], s76 offen offset:0 nt lds
  buffer_load_dwordx4 v4, s[44:47], s76 offen offset:1024 nt lds
  buffer_load_dwordx4 v4, s[44:47], s76 offen offset:2048 nt lds
  buffer_load_dwordx4 v4, s[44:47], s76 offen offset:3072 nt lds
  s_add_u32 m0, s76, 53248
  s_nop 0
  buffer_load_dwordx4 v5, s[48:51], s76 offen offset:0 nt lds
  buffer_load_dwordx4 v5, s[48:51], s76 offen offset:1024 nt lds
  buffer_load_dwordx4 v5, s[48:51], s76 offen offset:2048 nt lds
  buffer_load_dwordx4 v5, s[48:51], s76 offen offset:3072 nt lds
  s_add_u32 s76, s76, 4096
  s_cmp_lt_u32 s76, 32768
  s_cbranch_scc1 L_dma
L_poll:
  buffer_load_dword v57, v58, s[64:67], 0 offen offset:0 sc1
  s_waitcnt vmcnt(0)
  v_cmp_gt_u32 vcc, 4, v57
  s_cbranch_vccz L_polled
  s_sleep 8
  s_sub_u32 s0, s0, 1
  s_cbranch_scc0 L_poll
  s_mov_b32 s0, 0
L_polled:
  s_lshl_b32 s8, s4, 14
  buffer_load_dwordx4 v[64:67], v98, s[60:63], s8 offen offset:0 sc1
  buffer_load_dwordx4 v[68:71], v98, s[60:63], s8 offen offset:1024 sc1
  buffer_load_dwordx4 v[72:75], v98, s[60:63], s8 offen offset:2048 sc1
  buffer_load_dwordx4 v[76:79], v98, s[60:63], s8 offen offset:3072 sc1
  s_add_u32 s8, s8, 4096
  buffer_load_dwordx4 v[80:83], v98, s[60:63], s8 offen offset:0 sc1
  buffer_load_dwordx4 v[84:87], v98, s[60:63], s8 offen offset:1024 sc1
  buffer_load_dwordx4 v[88:91], v98, s[60:63], s8 offen offset:2048 sc1
  buffer_load_dwordx4 v[92:95], v98, s[60:63], s8 offen offset:3072 sc1
  s_add_u32 s8, s8, 4096
  buffer_load_dwordx4 v[28:31], v98, s[60:63], s8 offen offset:0 sc1
  buffer_load_dwordx4 v[32:35], v98, s[60:63], s8 offen offset:1024 sc1
  buffer_load_dwordx4 v[36:39], v98, s[60:63], s8 offen offset:2048 sc1
  buffer_load_dwordx4 v[40:43], v98, s[60:63], s8 offen offset:3072 sc1
  s_add_u32 s8, s8, 4096
  buffer_load_dwordx4 v[112:115], v98, s[60:63], s8 offen offset:0 sc1
  buffer_load_dwordx4 v[116:119], v98, s[60:63], s8 offen offset:1024 sc1
  buffer_load_dwordx4 v[120:123], v98, s[60:63], s8 offen offset:2048 sc1
  buffer_load_dwordx4 v[124:127], v98, s[60:63], s8 offen offset:3072 sc1
  s_lshl_b32 s8, s12, 17
  s_lshl_b32 s9, s13, 7
  s_add_u32 s8, s8, s9
  s_add_u32 s68, s24, s8
  s_addc_u32 s69, s25, 0
  s_mov_b32 s11, 0
  buffer_load_dwordx4 v[128:131], v7, s[68:71], s11 offen nt
  s_add_u32 s11, s11, 8192
  buffer_load_dwordx4 v[132:135], v7, s[68:71], s11 offen nt
  s_add_u32 s11, s11, 8192
  buffer_load_dwordx4 v[136:139], v7, s[68:71], s11 offen nt
  s_add_u32 s11, s11, 8192
  buffer_load_dwordx4 v[140:143], v7, s[68:71], s11 offen nt
  s_add_u32 s11, s11, 8192
  buffer_load_dwordx4 v[144:147], v7, s[68:71], s11 offen nt
  s_add_u32 s11, s11, 8192
  buffer_load_dwordx4 v[148:151], v7, s[68:71], s11 offen nt
  s_add_u32 s11, s11, 8192
  buffer_load_dwordx4 v[152:155], v7, s[68:71], s11 offen nt
  s_add_u32 s11, s11, 8192
  buffer_load_dwordx4 v[156:159], v7, s[68:71], s11 offen nt
  s_add_u32 s11, s11, 8192
  buffer_load_dwordx4 v[160:163], v7, s[68:71], s11 offen nt
  s_add_u32 s11, s11, 8192
  buffer_load_dwordx4 v[164:167], v7, s[68:71], s11 offen nt
  s_add_u32 s11, s11, 8192
  buffer_load_dwordx4 v[168:171], v7, s[68:71], s11 offen nt
  s_add_u32 s11, s11, 8192
  buffer_load_dwordx4 v[172:175], v7, s[68:71], s11 offen nt
  s_add_u32 s11, s11, 8192
  buffer_load_dwordx4 v[176:179], v7, s[68:71], s11 offen nt
  s_add_u32 s11, s11, 8192
  buffer_load_dwordx4 v[180:183], v7, s[68:71], s11 offen nt
  s_add_u32 s11, s11, 8192
  buffer_load_dwordx4 v[184:187], v7, s[68:71], s11 offen nt
  s_add_u32 s11, s11, 8192
  buffer_load_dwordx4 v[188:191], v7, s[68:71], s11 offen nt
  s_waitcnt vmcnt(28)
  v_add_f32 v64, v64, v68
  v_add_f32 v72, v72, v76
  v_add_f32 v65, v65, v69
  v_add_f32 v73, v73, v77
  v_add_f32 v66, v66, v70
  v_add_f32 v74, v74, v78
  v_add_f32 v67, v67, v71
  v_add_f32 v75, v75, v79
  v_add_f32 v64, v64, v72
  v_add_f32 v65, v65, v73
  v_add_f32 v66, v66, v74
  v_add_f32 v67, v67, v75
  v_mov_b32 v68, v64
  v_mov_b32 v69, v65
  v_mov_b32 v70, v66
  v_mov_b32 v71, v67
  v_permlane32_swap_b32 v64, v68
  v_permlane32_swap_b32 v65, v69
  v_permlane32_swap_b32 v66, v70
  v_permlane32_swap_b32 v67, v71
  v_add_f32 v64, v64, v68
  v_add_f32 v65, v65, v69
  v_add_f32 v66, v66, v70
  v_add_f32 v67, v67, v71
  v_cvt_pk_bf16_f32 v72, v64, v65
  v_cvt_pk_bf16_f32 v73, v66, v67
  ds_write_b64 v102, v[72:73] offset:16384
  s_waitcnt vmcnt(24)
  v_add_f32 v80, v80, v84
  v_add_f32 v88, v88, v92
  v_add_f32 v81, v81, v85
  v_add_f32 v89, v89, v93
  v_add_f32 v82, v82, v86
  v_add_f32 v90, v90, v94
  v_add_f32 v83, v83, v87
  v_add_f32 v91, v91, v95
  v_add_f32 v80, v80, v88
  v_add_f32 v81, v81, v89
  v_add_f32 v82, v82, v90
  v_add_f32 v83, v83, v91
  v_mov_b32 v84, v80
  v_mov_b32 v85, v81
  v_mov_b32 v86, v82
  v_mov_b32 v87, v83
  v_permlane32_swap_b32 v80, v84
  v_permlane32_swap_b32 v81, v85
  v_permlane32_swap_b32 v82, v86
  v_permlane32_swap_b32 v83, v87
  v_add_f32 v80, v80, v84
  v_add_f32 v81, v81, v85
  v_add_f32 v82, v82, v86
  v_add_f32 v83, v83, v87
  v_cvt_pk_bf16_f32 v88, v80, v81
  v_cvt_pk_bf16_f32 v89, v82, v83
  ds_write_b64 v102, v[88:89] offset:16640
  s_waitcnt vmcnt(20)
  v_add_f32 v28, v28, v32
  v_add_f32 v36, v36, v40
  v_add_f32 v29, v29, v33
  v_add_f32 v37, v37, v41
  v_add_f32 v30, v30, v34
  v_add_f32 v38, v38, v42
  v_add_f32 v31, v31, v35
  v_add_f32 v39, v39, v43
  v_add_f32 v28, v28, v36
  v_add_f32 v29, v29, v37
  v_add_f32 v30, v30, v38
  v_add_f32 v31, v31, v39
  v_mov_b32 v32, v28
  v_mov_b32 v33, v29
  v_mov_b32 v34, v30
  v_mov_b32 v35, v31
  v_permlane32_swap_b32 v28, v32
  v_permlane32_swap_b32 v29, v33
  v_permlane32_swap_b32 v30, v34
  v_permlane32_swap_b32 v31, v35
  v_add_f32 v28, v28, v32
  v_add_f32 v29, v29, v33
  v_add_f32 v30, v30, v34
  v_add_f32 v31, v31, v35
  v_cvt_pk_bf16_f32 v36, v28, v29
  v_cvt_pk_bf16_f32 v37, v30, v31
  ds_write_b64 v102, v[36:37] offset:16896
  s_waitcnt vmcnt(16)
  v_add_f32 v112, v112, v116
  v_add_f32 v120, v120, v124
  v_add_f32 v113, v113, v117
  v_add_f32 v121, v121, v125
  v_add_f32 v114, v114, v118
  v_add_f32 v122, v122, v126
  v_add_f32 v115, v115, v119
  v_add_f32 v123, v123, v127
  v_add_f32 v112, v112, v120
  v_add_f32 v113, v113, v121
  v_add_f32 v114, v114, v122
  v_add_f32 v115, v115, v123
  v_mov_b32 v116, v112
  v_mov_b32 v117, v113
  v_mov_b32 v118, v114
  v_mov_b32 v119, v115
  v_permlane32_swap_b32 v112, v116
  v_permlane32_swap_b32 v113, v117
  v_permlane32_swap_b32 v114, v118
  v_permlane32_swap_b32 v115, v119
  v_add_f32 v112, v112, v116
  v_add_f32 v113, v113, v117
  v_add_f32 v114, v114, v118
  v_add_f32 v115, v115, v119
  v_cvt_pk_bf16_f32 v120, v112, v113
  v_cvt_pk_bf16_f32 v121, v114, v115
  ds_write_b64 v102, v[120:121] offset:17152
  v_and_b32 v57, 3, v1
  v_lshl_add_u32 v57, v3, 2, v57
  v_lshlrev_b32 v57, 4, v57
  v_lshrrev_b32 v58, 2, v2
  v_lshl_add_u32 v57, v58, 8, v57
  ds_read_b128 v[16:19], v57 offset:16384
  v_mov_b32 v52, 0xff800000
  v_mov_b32 v53, 0
  v_mov_b32 v20, 0
  v_mov_b32 v21, 0
  v_mov_b32 v22, 0
  v_mov_b32 v23, 0
  v_mov_b32 v24, 0
  v_mov_b32 v25, 0
  v_mov_b32 v26, 0
  v_mov_b32 v27, 0
  s_mov_b32 s77, 8
  v_mov_b32 v63, v5
  s_waitcnt lgkmcnt(0)
L_aloop:
  ds_read_b128 v[192:195], v63 offset:20480
  ds_read_b128 v[196:199], v63 offset:21504
  ds_read_b128 v[200:203], v63 offset:22528
  ds_read_b128 v[204:207], v63 offset:23552
  ds_read_b128 v[208:211], v63 offset:53248
  ds_read_b128 v[212:215], v63 offset:54272
  ds_read_b128 v[216:219], v63 offset:55296
  ds_read_b128 v[220:223], v63 offset:56320
  v_add_u32 v63, 4096, v63
  s_waitcnt lgkmcnt(7)
  v_mfma_f32_16x16x32_bf16 v[28:31], v[192:195], v[16:19], 0
  s_waitcnt lgkmcnt(6)
  v_mfma_f32_16x16x32_bf16 v[32:35], v[196:199], v[16:19], 0
  s_waitcnt lgkmcnt(5)
  v_mfma_f32_16x16x32_bf16 v[36:39], v[200:203], v[16:19], 0
  s_waitcnt lgkmcnt(4)
  v_mfma_f32_16x16x32_bf16 v[40:43], v[204:207], v[16:19], 0
  s_nop 1
  v_mov_b32_dpp v48, v28 quad_perm:[0,0,0,0] row_mask:0xf bank_mask:0xf
  v_add_f32_dpp v48, v29, v48 quad_perm:[1,1,1,1] row_mask:0xf bank_mask:0xf
  v_add_f32_dpp v48, v30, v48 quad_perm:[2,2,2,2] row_mask:0xf bank_mask:0xf
  v_add_f32_dpp v48, v31, v48 quad_perm:[3,3,3,3] row_mask:0xf bank_mask:0xf
  v_mov_b32_dpp v49, v32 quad_perm:[0,0,0,0] row_mask:0xf bank_mask:0xf
  v_add_f32_dpp v49, v33, v49 quad_perm:[1,1,1,1] row_mask:0xf bank_mask:0xf
  v_add_f32_dpp v49, v34, v49 quad_perm:[2,2,2,2] row_mask:0xf bank_mask:0xf
  v_add_f32_dpp v49, v35, v49 quad_perm:[3,3,3,3] row_mask:0xf bank_mask:0xf
  v_mov_b32_dpp v50, v36 quad_perm:[0,0,0,0] row_mask:0xf bank_mask:0xf
  v_add_f32_dpp v50, v37, v50 quad_perm:[1,1,1,1] row_mask:0xf bank_mask:0xf
  v_add_f32_dpp v50, v38, v50 quad_perm:[2,2,2,2] row_mask:0xf bank_mask:0xf
  v_add_f32_dpp v50, v39, v50 quad_perm:[3,3,3,3] row_mask:0xf bank_mask:0xf
  v_mov_b32_dpp v51, v40 quad_perm:[0,0,0,0] row_mask:0xf bank_mask:0xf
  v_add_f32_dpp v51, v41, v51 quad_perm:[1,1,1,1] row_mask:0xf bank_mask:0xf
  v_add_f32_dpp v51, v42, v51 quad_perm:[2,2,2,2] row_mask:0xf bank_mask:0xf
  v_add_f32_dpp v51, v43, v51 quad_perm:[3,3,3,3] row_mask:0xf bank_mask:0xf
  v_cvt_pk_bf16_f32 v48, v48, v48
  v_and_b32 v48, 0xffff0000, v48
  v_mul_f32 v48, 0x3db504f3, v48
  v_cvt_pk_bf16_f32 v48, v48, v48
  v_and_b32 v48, 0xffff0000, v48
  v_cvt_pk_bf16_f32 v49, v49, v49
  v_and_b32 v49, 0xffff0000, v49
  v_mul_f32 v49, 0x3db504f3, v49
  v_cvt_pk_bf16_f32 v49, v49, v49
  v_and_b32 v49, 0xffff0000, v49
  v_cvt_pk_bf16_f32 v50, v50, v50
  v_and_b32 v50, 0xffff0000, v50
  v_mul_f32 v50, 0x3db504f3, v50
  v_cvt_pk_bf16_f32 v50, v50, v50
  v_and_b32 v50, 0xffff0000, v50
  v_cvt_pk_bf16_f32 v51, v51, v51
  v_and_b32 v51, 0xffff0000, v51
  v_mul_f32 v51, 0x3db504f3, v51
  v_cvt_pk_bf16_f32 v51, v51, v51
  v_and_b32 v51, 0xffff0000, v51
  v_max_f32 v57, v48, v49
  v_max3_f32 v57, v50, v51, v57
  v_mov_b32 v58, v57
  s_nop 1
  v_permlane16_swap_b32 v57, v58
  v_max_f32 v57, v57, v58
  v_mov_b32 v58, v57
  s_nop 1
  v_permlane32_swap_b32 v57, v58
  v_max3_f32 v57, v57, v58, v52
  v_sub_f32 v58, v52, v57
  v_mul_f32 v58, v55, v58
  v_exp_f32 v58, v58
  v_mov_b32 v52, v57
  v_mul_f32 v54, v56, v57
  v_mul_f32 v53, v58, v53
  v_mul_f32_dpp v20, v58, v20 row_newbcast:0 row_mask:0x3 bank_mask:0xf
  v_mul_f32_dpp v20, v58, v20 row_newbcast:4 row_mask:0xc bank_mask:0xf
  v_mul_f32_dpp v21, v58, v21 row_newbcast:0 row_mask:0x3 bank_mask:0xf
  v_mul_f32_dpp v21, v58, v21 row_newbcast:4 row_mask:0xc bank_mask:0xf
  v_mul_f32_dpp v22, v58, v22 row_newbcast:0 row_mask:0x3 bank_mask:0xf
  v_mul_f32_dpp v22, v58, v22 row_newbcast:4 row_mask:0xc bank_mask:0xf
  v_mul_f32_dpp v23, v58, v23 row_newbcast:0 row_mask:0x3 bank_mask:0xf
  v_mul_f32_dpp v23, v58, v23 row_newbcast:4 row_mask:0xc bank_mask:0xf
  v_mul_f32_dpp v24, v58, v24 row_newbcast:8 row_mask:0x3 bank_mask:0xf
  v_mul_f32_dpp v24, v58, v24 row_newbcast:12 row_mask:0xc bank_mask:0xf
  v_mul_f32_dpp v25, v58, v25 row_newbcast:8 row_mask:0x3 bank_mask:0xf
  v_mul_f32_dpp v25, v58, v25 row_newbcast:12 row_mask:0xc bank_mask:0xf
  v_mul_f32_dpp v26, v58, v26 row_newbcast:8 row_mask:0x3 bank_mask:0xf
  v_mul_f32_dpp v26, v58, v26 row_newbcast:12 row_mask:0xc bank_mask:0xf
  v_mul_f32_dpp v27, v58, v27 row_newbcast:8 row_mask:0x3 bank_mask:0xf
  v_mul_f32_dpp v27, v58, v27 row_newbcast:12 row_mask:0xc bank_mask:0xf
  v_fma_f32 v48, v48, v55, v54
  v_exp_f32 v48, v48
  v_fma_f32 v49, v49, v55, v54
  v_exp_f32 v49, v49
  v_fma_f32 v50, v50, v55, v54
  v_exp_f32 v50, v50
  v_fma_f32 v51, v51, v55, v54
  v_exp_f32 v51, v51
  v_add_f32 v53, v53, v48
  v_cvt_pk_bf16_f32 v48, v48, v48
  v_add_f32 v53, v53, v49
  v_cvt_pk_bf16_f32 v49, v49, v49
  v_add_f32 v53, v53, v50
  v_cvt_pk_bf16_f32 v50, v50, v50
  v_add_f32 v53, v53, v51
  v_cvt_pk_bf16_f32 v51, v51, v51
  s_waitcnt lgkmcnt(0)
  v_mov_b32_dpp v59, v48 row_newbcast:0 row_mask:0xf bank_mask:0x3
  v_mov_b32_dpp v59, v48 row_newbcast:4 row_mask:0xf bank_mask:0xc
  v_and_b32 v44, v59, v12
  v_and_b32 v45, v59, v13
  v_and_b32 v46, v59, v14
  v_and_b32 v47, v59, v15
  s_nop 1
  v_mfma_f32_16x16x32_bf16 v[20:23], v[44:47], v[208:211], v[20:23]
  v_mov_b32_dpp v59, v48 row_newbcast:8 row_mask:0xf bank_mask:0x3
  v_mov_b32_dpp v59, v48 row_newbcast:12 row_mask:0xf bank_mask:0xc
  v_and_b32 v44, v59, v12
  v_and_b32 v45, v59, v13
  v_and_b32 v46, v59, v14
  v_and_b32 v47, v59, v15
  s_nop 1
  v_mfma_f32_16x16x32_bf16 v[24:27], v[44:47], v[208:211], v[24:27]
  v_mov_b32_dpp v59, v49 row_newbcast:0 row_mask:0xf bank_mask:0x3
  v_mov_b32_dpp v59, v49 row_newbcast:4 row_mask:0xf bank_mask:0xc
  v_and_b32 v44, v59, v12
  v_and_b32 v45, v59, v13
  v_and_b32 v46, v59, v14
  v_and_b32 v47, v59, v15
  s_nop 1
  v_mfma_f32_16x16x32_bf16 v[20:23], v[44:47], v[212:215], v[20:23]
  v_mov_b32_dpp v59, v49 row_newbcast:8 row_mask:0xf bank_mask:0x3
  v_mov_b32_dpp v59, v49 row_newbcast:12 row_mask:0xf bank_mask:0xc
  v_and_b32 v44, v59, v12
  v_and_b32 v45, v59, v13
  v_and_b32 v46, v59, v14
  v_and_b32 v47, v59, v15
  s_nop 1
  v_mfma_f32_16x16x32_bf16 v[24:27], v[44:47], v[212:215], v[24:27]
  v_mov_b32_dpp v59, v50 row_newbcast:0 row_mask:0xf bank_mask:0x3
  v_mov_b32_dpp v59, v50 row_newbcast:4 row_mask:0xf bank_mask:0xc
  v_and_b32 v44, v59, v12
  v_and_b32 v45, v59, v13
  v_and_b32 v46, v59, v14
  v_and_b32 v47, v59, v15
  s_nop 1
  v_mfma_f32_16x16x32_bf16 v[20:23], v[44:47], v[216:219], v[20:23]
  v_mov_b32_dpp v59, v50 row_newbcast:8 row_mask:0xf bank_mask:0x3
  v_mov_b32_dpp v59, v50 row_newbcast:12 row_mask:0xf bank_mask:0xc
  v_and_b32 v44, v59, v12
  v_and_b32 v45, v59, v13
  v_and_b32 v46, v59, v14
  v_and_b32 v47, v59, v15
  s_nop 1
  v_mfma_f32_16x16x32_bf16 v[24:27], v[44:47], v[216:219], v[24:27]
  v_mov_b32_dpp v59, v51 row_newbcast:0 row_mask:0xf bank_mask:0x3
  v_mov_b32_dpp v59, v51 row_newbcast:4 row_mask:0xf bank_mask:0xc
  v_and_b32 v44, v59, v12
  v_and_b32 v45, v59, v13
  v_and_b32 v46, v59, v14
  v_and_b32 v47, v59, v15
  s_nop 1
  v_mfma_f32_16x16x32_bf16 v[20:23], v[44:47], v[220:223], v[20:23]
  v_mov_b32_dpp v59, v51 row_newbcast:8 row_mask:0xf bank_mask:0x3
  v_mov_b32_dpp v59, v51 row_newbcast:12 row_mask:0xf bank_mask:0xc
  v_and_b32 v44, v59, v12
  v_and_b32 v45, v59, v13
  v_and_b32 v46, v59, v14
  v_and_b32 v47, v59, v15
  s_nop 1
  v_mfma_f32_16x16x32_bf16 v[24:27], v[44:47], v[220:223], v[24:27]
  s_sub_u32 s77, s77, 1
  s_cmp_lg_u32 s77, 0
  s_cbranch_scc1 L_aloop
  s_nop 7
  v_mov_b32 v58, v53
  s_nop 1
  v_permlane16_swap_b32 v53, v58
  v_add_f32 v53, v53, v58
  v_mov_b32 v58, v53
  s_nop 1
  v_permlane32_swap_b32 v53, v58
  v_add_f32 v53, v53, v58
  v_mov_b32 v59, -2
  v_min_u32 v52, v59, v52
  v_min_u32 v53, v59, v53
  v_lshrrev_b32 v57, 1, v3
  v_mul_u32_u24 v57, 16896, v57
  v_add_u32 v57, v99, v57
  v_lshrrev_b32 v58, 2, v2
  v_mul_u32_u24 v58, 16896, v58
  s_add_u32 s8, s14, 33792
  v_min_u32 v20, v59, v20
  v_min_u32 v21, v59, v21
  v_min_u32 v22, v59, v22
  v_min_u32 v23, v59, v23
  v_min_u32 v24, v59, v24
  v_min_u32 v25, v59, v25
  v_min_u32 v26, v59, v26
  v_min_u32 v27, v59, v27
  buffer_store_dwordx4 v[20:23], v57, s[60:63], s14 offen sc1
  buffer_store_dwordx4 v[24:27], v57, s[60:63], s8 offen sc1
  s_mov_b64 exec, 0x1111
  buffer_store_dwordx2 v[52:53], v58, s[60:63], s14 offen offset:512 sc1
  s_mov_b64 exec, -1
  s_mul_i32 s81, s12, 16896
  s_add_u32 s81, s81, 131072
  s_mov_b32 s82, 4
  s_mov_b32 s83, s42
  s_lshl_b32 s84, s4, 13
  s_add_u32 s86, s84, 872448
  s_add_u32 s84, s84, 806912
  s_lshl_b32 s85, s4, 7
  s_cmp_eq_u32 s5, s4
  s_cselect_b32 s84, s84, -1
  s_cselect_b32 s86, s86, -1
  s_mov_b32 s79, 0
L_ph:
  v_mov_b32 v52, 0xff800000
  v_mov_b32 v53, 0
  v_mov_b32 v108, 0
  v_mov_b32 v109, 0
  v_mov_b32 v110, 0
  v_mov_b32 v111, 0
L_chunk:
  s_mov_b64 s[16:17], -1
  s_mov_b64 s[18:19], -1
  s_mov_b64 s[20:21], -1
  s_mov_b64 s[22:23], -1
L_chre:
  s_mov_b64 exec, s[16:17]
  buffer_load_dwordx4 v[64:67], v96, s[60:63], s81 offen offset:0 sc1
  buffer_load_dwordx2 v[80:81], v97, s[60:63], s81 offen offset:512 sc1
  s_mov_b64 exec, s[18:19]
  buffer_load_dwordx4 v[68:71], v96, s[60:63], s81 offen offset:1056 sc1
  buffer_load_dwordx2 v[82:83], v97, s[60:63], s81 offen offset:1568 sc1
  s_mov_b64 exec, s[20:21]
  buffer_load_dwordx4 v[72:75], v96, s[60:63], s81 offen offset:2112 sc1
  buffer_load_dwordx2 v[84:85], v97, s[60:63], s81 offen offset:2624 sc1
  s_mov_b64 exec, s[22:23]
  buffer_load_dwordx4 v[76:79], v96, s[60:63], s81 offen offset:3168 sc1
  buffer_load_dwordx2 v[86:87], v97, s[60:63], s81 offen offset:3680 sc1
  s_mov_b64 exec, -1
  s_waitcnt vmcnt(0)
  v_max3_u32 v57, v64, v65, v66
  v_max3_u32 v57, v67, v80, v57
  v_max_u32 v57, v81, v57
  v_max3_u32 v58, v68, v69, v70
  v_max3_u32 v58, v71, v82, v58
  v_max_u32 v58, v83, v58
  v_max3_u32 v59, v72, v73, v74
  v_max3_u32 v59, v75, v84, v59
  v_max_u32 v59, v85, v59
  v_max3_u32 v60, v76, v77, v78
  v_max3_u32 v60, v79, v86, v60
  v_max_u32 v60, v87, v60
  v_cmp_eq_u32 s[16:17], -1, v57
  v_cmp_eq_u32 s[18:19], -1, v58
  v_cmp_eq_u32 s[20:21], -1, v59
  v_cmp_eq_u32 s[22:23], -1, v60
  s_or_b64 s[8:9], s[16:17], s[18:19]
  s_or_b64 s[26:27], s[20:21], s[22:23]
  s_or_b64 s[8:9], s[8:9], s[26:27]
  s_cbranch_scc0 L_chok
  s_sleep 2
  s_sub_u32 s0, s0, 1
  s_cbranch_scc0 L_chre
  s_mov_b32 s0, 0
L_chok:
  s_call_b64 s[10:11], L_math8
  s_add_u32 s81, s81, 4224
  s_sub_u32 s82, s82, 1
  s_cmp_lg_u32 s82, 0
  s_cbranch_scc1 L_chunk
  s_call_b64 s[10:11], L_xhalf
  v_rcp_f32 v57, v53
  s_nop 0
  v_mul_f32 v108, v57, v108
  v_mul_f32 v109, v57, v109
  v_mul_f32 v110, v57, v110
  v_mul_f32 v111, v57, v111
  v_cvt_pk_bf16_f32 v108, v108, v108
  v_cvt_pk_bf16_f32 v109, v109, v109
  v_cvt_pk_bf16_f32 v110, v110, v110
  v_cvt_pk_bf16_f32 v111, v111, v111
  ds_write_b32 v101, v108 offset:17408
  ds_write_b32 v101, v109 offset:17472
  ds_write_b32 v101, v110 offset:17536
  ds_write_b32 v101, v111 offset:17600
  ds_read_b128 v[112:115], v100 offset:17408
  ds_read_b128 v[116:119], v100 offset:17424
  ds_read_b128 v[120:123], v100 offset:17440
  ds_read_b128 v[124:127], v100 offset:17456
  s_waitcnt lgkmcnt(3)
  v_and_b32 v44, v112, v12
  v_and_b32 v45, v112, v13
  v_and_b32 v46, v112, v14
  v_and_b32 v47, v112, v15
  s_nop 1
  v_mfma_f32_16x16x32_bf16 v[28:31], v[44:47], v[128:131], 0
  v_and_b32 v44, v113, v12
  v_and_b32 v45, v113, v13
  v_and_b32 v46, v113, v14
  v_and_b32 v47, v113, v15
  s_nop 1
  v_mfma_f32_16x16x32_bf16 v[28:31], v[44:47], v[132:135], v[28:31]
  v_and_b32 v44, v114, v12
  v_and_b32 v45, v114, v13
  v_and_b32 v46, v114, v14
  v_and_b32 v47, v114, v15
  s_nop 1
  v_mfma_f32_16x16x32_bf16 v[28:31], v[44:47], v[136:139], v[28:31]
  v_and_b32 v44, v115, v12
  v_and_b32 v45, v115, v13
  v_and_b32 v46, v115, v14
  v_and_b32 v47, v115, v15
  s_nop 1
  v_mfma_f32_16x16x32_bf16 v[28:31], v[44:47], v[140:143], v[28:31]
  s_waitcnt lgkmcnt(2)
  v_and_b32 v44, v116, v12
  v_and_b32 v45, v116, v13
  v_and_b32 v46, v116, v14
  v_and_b32 v47, v116, v15
  s_nop 1
  v_mfma_f32_16x16x32_bf16 v[28:31], v[44:47], v[144:147], v[28:31]
  v_and_b32 v44, v117, v12
  v_and_b32 v45, v117, v13
  v_and_b32 v46, v117, v14
  v_and_b32 v47, v117, v15
  s_nop 1
  v_mfma_f32_16x16x32_bf16 v[28:31], v[44:47], v[148:151], v[28:31]
  v_and_b32 v44, v118, v12
  v_and_b32 v45, v118, v13
  v_and_b32 v46, v118, v14
  v_and_b32 v47, v118, v15
  s_nop 1
  v_mfma_f32_16x16x32_bf16 v[28:31], v[44:47], v[152:155], v[28:31]
  v_and_b32 v44, v119, v12
  v_and_b32 v45, v119, v13
  v_and_b32 v46, v119, v14
  v_and_b32 v47, v119, v15
  s_nop 1
  v_mfma_f32_16x16x32_bf16 v[28:31], v[44:47], v[156:159], v[28:31]
  s_waitcnt lgkmcnt(1)
  v_and_b32 v44, v120, v12
  v_and_b32 v45, v120, v13
  v_and_b32 v46, v120, v14
  v_and_b32 v47, v120, v15
  s_nop 1
  v_mfma_f32_16x16x32_bf16 v[28:31], v[44:47], v[160:163], v[28:31]
  v_and_b32 v44, v121, v12
  v_and_b32 v45, v121, v13
  v_and_b32 v46, v121, v14
  v_and_b32 v47, v121, v15
  s_nop 1
  v_mfma_f32_16x16x32_bf16 v[28:31], v[44:47], v[164:167], v[28:31]
  v_and_b32 v44, v122, v12
  v_and_b32 v45, v122, v13
  v_and_b32 v46, v122, v14
  v_and_b32 v47, v122, v15
  s_nop 1
  v_mfma_f32_16x16x32_bf16 v[28:31], v[44:47], v[168:171], v[28:31]
  v_and_b32 v44, v123, v12
  v_and_b32 v45, v123, v13
  v_and_b32 v46, v123, v14
  v_and_b32 v47, v123, v15
  s_nop 1
  v_mfma_f32_16x16x32_bf16 v[28:31], v[44:47], v[172:175], v[28:31]
  s_waitcnt lgkmcnt(0)
  v_and_b32 v44, v124, v12
  v_and_b32 v45, v124, v13
  v_and_b32 v46, v124, v14
  v_and_b32 v47, v124, v15
  s_nop 1
  v_mfma_f32_16x16x32_bf16 v[28:31], v[44:47], v[176:179], v[28:31]
  v_and_b32 v44, v125, v12
  v_and_b32 v45, v125, v13
  v_and_b32 v46, v125, v14
  v_and_b32 v47, v125, v15
  s_nop 1
  v_mfma_f32_16x16x32_bf16 v[28:31], v[44:47], v[180:183], v[28:31]
  v_and_b32 v44, v126, v12
  v_and_b32 v45, v126, v13
  v_and_b32 v46, v126, v14
  v_and_b32 v47, v126, v15
  s_nop 1
  v_mfma_f32_16x16x32_bf16 v[28:31], v[44:47], v[184:187], v[28:31]
  v_and_b32 v44, v127, v12
  v_and_b32 v45, v127, v13
  v_and_b32 v46, v127, v14
  v_and_b32 v47, v127, v15
  s_nop 1
  v_mfma_f32_16x16x32_bf16 v[28:31], v[44:47], v[188:191], v[28:31]
  s_nop 7
  v_mov_b32 v32, v28
  v_mov_b32 v33, v29
  v_mov_b32 v34, v30
  v_mov_b32 v35, v31
  v_permlane32_swap_b32 v28, v32
  v_permlane32_swap_b32 v29, v33
  v_permlane32_swap_b32 v30, v34
  v_permlane32_swap_b32 v31, v35
  v_add_f32_dpp v28, v32, v28 row_ror:8 row_mask:0xf bank_mask:0xf
  v_add_f32_dpp v29, v33, v29 row_ror:8 row_mask:0xf bank_mask:0xf
  v_add_f32_dpp v30, v34, v30 row_ror:8 row_mask:0xf bank_mask:0xf
  v_add_f32_dpp v31, v35, v31 row_ror:8 row_mask:0xf bank_mask:0xf
  v_mov_b32 v59, -2
  v_min_u32 v28, v59, v28
  v_min_u32 v29, v59, v29
  v_min_u32 v30, v59, v30
  v_min_u32 v31, v59, v31
  s_mov_b64 exec, 0x00ff00ff
  buffer_store_dwordx4 v[28:31], v99, s[60:63], s83 offen sc1
  s_mov_b64 exec, -1
  s_cmp_lg_u32 s79, 0
  s_cbranch_scc1 L_nowob
  s_lshl_b32 s8, s6, 17
  s_lshl_b32 s9, s7, 7
  s_add_u32 s8, s8, s9
  s_add_u32 s68, s34, s8
  s_addc_u32 s69, s35, 0
  s_mov_b32 s11, 0
  buffer_load_dwordx4 v[128:131], v7, s[68:71], s11 offen nt
  s_add_u32 s11, s11, 8192
  buffer_load_dwordx4 v[132:135], v7, s[68:71], s11 offen nt
  s_add_u32 s11, s11, 8192
  buffer_load_dwordx4 v[136:139], v7, s[68:71], s11 offen nt
  s_add_u32 s11, s11, 8192
  buffer_load_dwordx4 v[140:143], v7, s[68:71], s11 offen nt
  s_add_u32 s11, s11, 8192
  buffer_load_dwordx4 v[144:147], v7, s[68:71], s11 offen nt
  s_add_u32 s11, s11, 8192
  buffer_load_dwordx4 v[148:151], v7, s[68:71], s11 offen nt
  s_add_u32 s11, s11, 8192
  buffer_load_dwordx4 v[152:155], v7, s[68:71], s11 offen nt
  s_add_u32 s11, s11, 8192
  buffer_load_dwordx4 v[156:159], v7, s[68:71], s11 offen nt
  s_add_u32 s11, s11, 8192
  buffer_load_dwordx4 v[160:163], v7, s[68:71], s11 offen nt
  s_add_u32 s11, s11, 8192
  buffer_load_dwordx4 v[164:167], v7, s[68:71], s11 offen nt
  s_add_u32 s11, s11, 8192
  buffer_load_dwordx4 v[168:171], v7, s[68:71], s11 offen nt
  s_add_u32 s11, s11, 8192
  buffer_load_dwordx4 v[172:175], v7, s[68:71], s11 offen nt
  s_add_u32 s11, s11, 8192
  buffer_load_dwordx4 v[176:179], v7, s[68:71], s11 offen nt
  s_add_u32 s11, s11, 8192
  buffer_load_dwordx4 v[180:183], v7, s[68:71], s11 offen nt
  s_add_u32 s11, s11, 8192
  buffer_load_dwordx4 v[184:187], v7, s[68:71], s11 offen nt
  s_add_u32 s11, s11, 8192
  buffer_load_dwordx4 v[188:191], v7, s[68:71], s11 offen nt
L_nowob:
  s_cmp_eq_u32 s84, -1
  s_cbranch_scc1 L_nofin
  s_add_u32 s8, s84, 4096
L_fin:
  buffer_load_dwordx4 v[64:67], v5, s[60:63], s84 offen offset:0 sc1
  buffer_load_dwordx4 v[68:71], v5, s[60:63], s84 offen offset:1024 sc1
  buffer_load_dwordx4 v[72:75], v5, s[60:63], s84 offen offset:2048 sc1
  buffer_load_dwordx4 v[76:79], v5, s[60:63], s84 offen offset:3072 sc1
  buffer_load_dwordx4 v[80:83], v5, s[60:63], s8 offen offset:0 sc1
  buffer_load_dwordx4 v[84:87], v5, s[60:63], s8 offen offset:1024 sc1
  buffer_load_dwordx4 v[88:91], v5, s[60:63], s8 offen offset:2048 sc1
  buffer_load_dwordx4 v[92:95], v5, s[60:63], s8 offen offset:3072 sc1
  s_waitcnt vmcnt(0)
  v_max3_u32 v57, v64, v65, v66
  v_max3_u32 v57, v67, v68, v57
  v_max3_u32 v57, v69, v70, v57
  v_max3_u32 v57, v71, v72, v57
  v_max3_u32 v57, v73, v74, v57
  v_max3_u32 v57, v75, v76, v57
  v_max3_u32 v57, v77, v78, v57
  v_max3_u32 v57, v79, v80, v57
  v_max3_u32 v57, v81, v82, v57
  v_max3_u32 v57, v83, v84, v57
  v_max3_u32 v57, v85, v86, v57
  v_max3_u32 v57, v87, v88, v57
  v_max3_u32 v57, v89, v90, v57
  v_max3_u32 v57, v91, v92, v57
  v_max3_u32 v57, v93, v94, v57
  v_max_u32 v57, v95, v57
  v_cmp_eq_u32 vcc, -1, v57
  s_cbranch_vccz L_finok
  s_sleep 1
  s_sub_u32 s0, s0, 1
  s_cbranch_scc0 L_fin
  s_mov_b32 s0, 0
L_finok:
  v_add_f32 v64, v64, v80
  v_add_f32 v65, v65, v81
  v_add_f32 v66, v66, v82
  v_add_f32 v67, v67, v83
  v_add_f32 v68, v68, v84
  v_add_f32 v69, v69, v85
  v_add_f32 v70, v70, v86
  v_add_f32 v71, v71, v87
  v_add_f32 v72, v72, v88
  v_add_f32 v73, v73, v89
  v_add_f32 v74, v74, v90
  v_add_f32 v75, v75, v91
  v_add_f32 v76, v76, v92
  v_add_f32 v77, v77, v93
  v_add_f32 v78, v78, v94
  v_add_f32 v79, v79, v95
  v_add_f32 v64, v64, v72
  v_add_f32 v65, v65, v73
  v_add_f32 v66, v66, v74
  v_add_f32 v67, v67, v75
  v_add_f32 v68, v68, v76
  v_add_f32 v69, v69, v77
  v_add_f32 v70, v70, v78
  v_add_f32 v71, v71, v79
  v_add_f32 v64, v64, v68
  v_add_f32 v65, v65, v69
  v_add_f32 v66, v66, v70
  v_add_f32 v67, v67, v71
  v_mov_b32 v68, v64
  v_mov_b32 v69, v65
  v_mov_b32 v70, v66
  v_mov_b32 v71, v67
  v_permlane16_swap_b32 v64, v68
  v_permlane16_swap_b32 v65, v69
  v_permlane16_swap_b32 v66, v70
  v_permlane16_swap_b32 v67, v71
  v_add_f32 v64, v64, v68
  v_add_f32 v65, v65, v69
  v_add_f32 v66, v66, v70
  v_add_f32 v67, v67, v71
  v_mov_b32 v68, v64
  v_mov_b32 v69, v65
  v_mov_b32 v70, v66
  v_mov_b32 v71, v67
  v_permlane32_swap_b32 v64, v68
  v_permlane32_swap_b32 v65, v69
  v_permlane32_swap_b32 v66, v70
  v_permlane32_swap_b32 v67, v71
  v_add_f32 v64, v64, v68
  v_add_f32 v65, v65, v69
  v_add_f32 v66, v66, v70
  v_add_f32 v67, v67, v71
  v_cvt_pk_bf16_f32 v72, v64, v65
  v_cvt_pk_bf16_f32 v73, v66, v67
  v_lshlrev_b32 v57, 3, v2
  s_mov_b64 exec, 0xffff
  buffer_store_dwordx2 v[72:73], v57, s[72:75], s85 offen
  s_mov_b64 exec, -1
L_nofin:
  s_cmp_lg_u32 s79, 0
  s_cbranch_scc1 L_cend
  s_lshl_b32 s87, s2, 10
  s_add_u32 s87, s87, 937984
L_tail:
  v_mov_b32 v52, 0xff800000
  v_mov_b32 v53, 0
  v_mov_b32 v108, 0
  v_mov_b32 v109, 0
  v_mov_b32 v110, 0
  v_mov_b32 v111, 0
  ds_read_b128 v[64:67], v96 offset:8192
  ds_read_b64 v[80:81], v97 offset:8704
  ds_read_b128 v[68:71], v96 offset:9248
  ds_read_b64 v[82:83], v97 offset:9760
  ds_read_b128 v[72:75], v96 offset:10304
  ds_read_b64 v[84:85], v97 offset:10816
  ds_read_b128 v[76:79], v96 offset:11360
  ds_read_b64 v[86:87], v97 offset:11872
  s_waitcnt lgkmcnt(0)
  s_call_b64 s[10:11], L_math8
  s_call_b64 s[10:11], L_xhalf
  v_mov_b32 v59, -2
  v_min_u32 v108, v59, v108
  v_min_u32 v109, v59, v109
  v_min_u32 v110, v59, v110
  v_min_u32 v111, v59, v111
  v_min_u32 v52, v59, v52
  v_min_u32 v53, v59, v53
  s_mov_b32 exec_hi, 0
  buffer_store_dwordx4 v[108:111], v5, s[60:63], s87 offen sc1
  s_mov_b64 exec, 1
  buffer_store_dwordx2 v[52:53], v5, s[60:63], s87 offen offset:512 sc1
  s_mov_b64 exec, -1
  s_cmp_lg_u32 s79, 0
  s_cbranch_scc1 L_ph
  s_mov_b32 s79, 1
  s_mov_b32 s87, s15
  s_mul_i32 s81, s6, 4224
  s_add_u32 s81, s81, 671744
  s_mov_b32 s82, 1
  s_mov_b32 s83, s43
  s_mov_b32 s84, s86
  s_add_u32 s85, s85, 1024
  s_waitcnt vmcnt(0)
  s_barrier
  s_branch L_tail
L_cend:
L_end:
  s_endpgm
L_math8:
  s_nop 1
  v_max_f32 v57, v80, v82
  v_max3_f32 v57, v84, v86, v57
  v_mov_b32 v58, v57
  s_nop 1
  v_permlane32_swap_b32 v57, v58
  v_max3_f32 v57, v57, v58, v52
  v_mul_f32 v54, v56, v57
  v_fma_f32 v58, v52, v55, v54
  v_mov_b32 v52, v57
  v_exp_f32 v58, v58
  v_fma_f32 v59, v80, v55, v54
  v_fma_f32 v60, v82, v55, v54
  v_fma_f32 v61, v84, v55, v54
  v_fma_f32 v62, v86, v55, v54
  v_exp_f32 v59, v59
  v_exp_f32 v60, v60
  v_exp_f32 v61, v61
  v_exp_f32 v62, v62
  v_mul_f32 v53, v58, v53
  v_mul_f32 v108, v58, v108
  v_mul_f32 v109, v58, v109
  v_mul_f32 v110, v58, v110
  v_mul_f32 v111, v58, v111
  v_fmac_f32 v53, v59, v81
  v_fmac_f32 v108, v59, v64
  v_fmac_f32 v109, v59, v65
  v_fmac_f32 v110, v59, v66
  v_fmac_f32 v111, v59, v67
  v_fmac_f32 v53, v60, v83
  v_fmac_f32 v108, v60, v68
  v_fmac_f32 v109, v60, v69
  v_fmac_f32 v110, v60, v70
  v_fmac_f32 v111, v60, v71
  v_fmac_f32 v53, v61, v85
  v_fmac_f32 v108, v61, v72
  v_fmac_f32 v109, v61, v73
  v_fmac_f32 v110, v61, v74
  v_fmac_f32 v111, v61, v75
  v_fmac_f32 v53, v62, v87
  v_fmac_f32 v108, v62, v76
  v_fmac_f32 v109, v62, v77
  v_fmac_f32 v110, v62, v78
  v_fmac_f32 v111, v62, v79
  s_setpc_b64 s[10:11]
L_xhalf:
  s_nop 1
  v_mov_b32 v57, v53
  v_mov_b32 v58, v108
  v_mov_b32 v59, v109
  v_mov_b32 v60, v110
  v_mov_b32 v61, v111
  v_permlane32_swap_b32 v53, v57
  v_permlane32_swap_b32 v108, v58
  v_permlane32_swap_b32 v109, v59
  v_permlane32_swap_b32 v110, v60
  v_permlane32_swap_b32 v111, v61
  v_add_f32 v53, v53, v57
  v_add_f32 v108, v108, v58
  v_add_f32 v109, v109, v59
  v_add_f32 v110, v110, v60
  v_add_f32 v111, v111, v61
  s_setpc_b64 s[10:11]
L_codeend:
.section .rodata,"a"
.p2align 6
.amdhsa_kernel concat_heads__sliding_block_cached__mha_block_cached__decode_kernel
  .amdhsa_next_free_vgpr 256
  .amdhsa_next_free_sgpr 102
  .amdhsa_accum_offset 256
  .amdhsa_group_segment_fixed_size 0
  .amdhsa_kernarg_size 104
  .amdhsa_user_sgpr_count 2
  .amdhsa_user_sgpr_kernarg_segment_ptr 1
  .amdhsa_system_sgpr_workgroup_id_x 1
.end_amdhsa_kernel
```
